```python
import torch

def _softmax(x, axis=-1):
    return torch.softmax(x, dim=axis)
def _gelu(x):
    return torch.nn.functional.gelu(x, approximate="tanh")
def _silu(x):
    return torch.nn.functional.silu(x)
def _sigmoid(x):
    return torch.sigmoid(x)
def _layernorm(x, axis=-1, eps=1e-5):
    m = x.mean(dim=axis, keepdim=True)
    v = x.var(dim=axis, keepdim=True, unbiased=False)
    return (x - m) / torch.sqrt(v + eps)
def _scatter_add(tgt, idx, src, axis=0):
    return tgt.clone().index_add_(axis, idx, src)
def _segment_sum(src, seg, n):
    out = torch.zeros((n,) + src.shape[1:], dtype=src.dtype)
    return out.index_add_(0, seg, src)
def _pad(x, pw):
    flat = tuple(v for pair in reversed(pw) for v in pair)
    return torch.nn.functional.pad(x, flat)

kernel_name = 'gated_mix__mha_block__geglu_ffn__prompt'

def setup_inputs():

    _w = (lambda a: (lambda t: t.to(torch.bfloat16) if t.is_floating_point() else t)(torch.as_tensor(a)))
    def _A_setup():
        B, S, D, H = 1, 2048, 448, 16
        return {
            "x": _w((lambda *s: torch.randn(*s, dtype=torch.bfloat16) * 0.05)(B, S, D)),
            "wqkv": _w((lambda *s: torch.randn(*s, dtype=torch.bfloat16) * 0.8)(D, 3 * D)),
            "wo": _w((lambda *s: torch.randn(*s, dtype=torch.bfloat16) * 0.05)(D, D)),
        }
    _A_in = _A_setup()

    def _B_setup():
        B, S, D, F = 1, 2048, 448, 1792
        return {
            "x": _w((lambda *s: torch.randn(*s, dtype=torch.bfloat16) * 0.05)(B, S, D)),
            "w_gate": _w((lambda *s: torch.randn(*s, dtype=torch.bfloat16) * 0.1)(D, F)),
            "w_up": _w((lambda *s: torch.randn(*s, dtype=torch.bfloat16) * 0.1)(D, F)),
            "w_down": _w((lambda *s: torch.randn(*s, dtype=torch.bfloat16) * 0.1)(F, D)),
        }
    _B_in = _B_setup()

    return {
        "A_x": _A_in["x"],
        "A_wqkv": _A_in["wqkv"],
        "A_wo": _A_in["wo"],
        "B_x": _B_in["x"],
        "B_w_gate": _B_in["w_gate"],
        "B_w_up": _B_in["w_up"],
        "B_w_down": _B_in["w_down"],
        "gate_w": _w((lambda *s: torch.randn(*s, dtype=torch.bfloat16) * 0.05)(448) * 16.0),
    }

def reference(A_x, A_wqkv, A_wo, B_x, B_w_gate, B_w_up, B_w_down, gate_w):
    def _A_ref(x, wqkv, wo):
        B, S, D = x.shape
        H = 16
        Dh = D // H
        qkv = (lambda x, *d: x.permute(*d))((x @ wqkv).reshape(B, S, 3, H, Dh), 2, 0, 3, 1, 4)
        q, k, v = qkv[0], qkv[1], qkv[2]
        scores = torch.einsum("bhqd,bhkd->bhqk", q, k) * (Dh ** -0.5)
        p = _softmax(scores, axis=-1)
        o = torch.einsum("bhqk,bhkd->bhqd", p, v)
        return (lambda x, *d: x.permute(*d))(o, 0, 2, 1, 3).reshape(B, S, D) @ wo

    def _B_ref(x, w_gate, w_up, w_down):
        return (_gelu(x @ w_gate) * (x @ w_up)) @ w_down

    x = A_x
    g = _sigmoid((x * gate_w).sum(-1, keepdims=True))
    a = _A_ref(x, A_wqkv, A_wo)
    b = _B_ref(x, B_w_gate, B_w_up, B_w_down)
    return g * a + (1 - g) * b
```

```asm
; @launch grid=(256,1,1) block=(512,1,1) lds=163840
.amdgcn_target "amdgcn-amd-amdhsa--gfx950"
.text
.globl gated_mix__mha_block__geglu_ffn__prompt_kernel
.p2align 8
.type gated_mix__mha_block__geglu_ffn__prompt_kernel,@function
gated_mix__mha_block__geglu_ffn__prompt_kernel:
    s_cmp_ge_u32 s2, 256
    s_cbranch_scc1 L_end
    s_load_dwordx16 s[72:87], s[0:1], 0
    s_load_dwordx4 s[88:91], s[0:1], 64
    s_load_dwordx2 s[92:93], s[0:1], 80
    s_lshr_b32 s41, s2, 3
    s_getpc_b64 s[96:97]
L_pc:
    s_lshl_b32 s50, s41, 13
    v_lshlrev_b32 v2, 4, v0
    v_add_u32 v2, s50, v2
    v_and_b32 v2, 0xffff, v2
    v_min_u32 v2, L_codeend-L_pc-16, v2
    v_mov_b32 v3, s97
    v_add_co_u32 v2, vcc, s96, v2
    s_nop 1
    v_addc_co_u32 v3, vcc, 0, v3, vcc
    global_load_dwordx4 v[252:255], v[2:3], off
    v_lshrrev_b32 v1, 6, v0
    s_nop 0
    v_readfirstlane_b32 s3, v1
    v_and_b32 v1, 63, v0
    s_and_b32 s40, s2, 7
    s_and_b32 s44, s3, 3
    s_lshr_b32 s48, s3, 2
    s_sub_u32 s54, s41, 4
    s_mul_i32 s50, s54, 37
    s_lshr_b32 s50, s50, 8
    s_mul_i32 s51, s50, 7
    s_sub_u32 s65, s54, s51
    s_cmp_lt_u32 s41, 4
    s_cselect_b32 s50, s41, s50
    s_lshr_b32 s52, s40, 1
    s_lshl_b32 s52, s52, 2
    s_add_u32 s42, s52, s50
    s_and_b32 s53, s40, 1
    s_mul_i32 s53, s53, 7
    s_add_u32 s43, s53, s65
    s_lshl_b32 s64, s40, 2
    s_add_u32 s64, s64, s50
    s_lshl_b32 s47, s3, 11
    s_lshl_b32 s51, s42, 7
    s_lshl_b32 s52, s3, 4
    s_add_u32 s51, s51, s52
    v_lshrrev_b32 v18, 3, v1
    v_add_u32 v19, s51, v18
    v_mul_u32_u24 v19, 896, v19
    v_lshrrev_b32 v20, 4, v1
    v_and_b32 v21, 7, v1
    v_xor_b32 v21, v21, v20
    v_lshl_add_u32 v2, v21, 4, v19
    v_xor_b32 v21, 4, v21
    v_lshl_add_u32 v3, v21, 4, v19
    v_add_u32 v3, 7168, v3
    s_cmp_lt_u32 s41, 4
    s_cbranch_scc1 L_v
    v_bfe_u32 v21, v1, 1, 2
    v_bfe_u32 v20, v1, 4, 1
    v_lshlrev_b32 v20, 1, v20
    v_xor_b32 v21, v21, v20
    v_lshlrev_b32 v21, 5, v21
    v_and_b32 v20, 1, v1
    v_lshl_add_u32 v21, v20, 4, v21
    v_add_u32 v19, s52, v18
    v_mul_u32_u24 v19, 2688, v19
    s_lshl_b32 s51, s43, 7
    v_add3_u32 v4, v19, v21, s51
    s_waitcnt lgkmcnt(0)
    s_mov_b32 s4, s72
    s_mov_b32 s5, s73
    s_mov_b32 s6, 1835008
    s_mov_b32 s7, 0x00020000
    s_mov_b32 s8, s74
    s_mov_b32 s9, s75
    s_mov_b32 s10, 1204224
    s_mov_b32 s11, 0x00020000
    s_add_u32 m0, s47, 0
    s_movk_i32 s56, 0
    buffer_load_dwordx4 v2, s[4:7], s56 offen lds
    s_add_u32 m0, s47, 1024
    s_movk_i32 s56, 0
    buffer_load_dwordx4 v3, s[4:7], s56 offen lds
    s_add_u32 m0, s47, 16384
    s_mov_b32 s56, 0
    buffer_load_dwordx4 v4, s[8:11], s56 offen lds
    s_add_u32 m0, s47, 17408
    s_mov_b32 s56, 21504
    buffer_load_dwordx4 v4, s[8:11], s56 offen lds
    s_lshl_b32 s51, s44, 3
    v_add_u32 v19, s51, v18
    v_mul_u32_u24 v19, 3584, v19
    s_lshl_b32 s51, s48, 5
    v_xor_b32 v21, s51, v21
    s_lshl_b32 s51, s43, 8
    v_add3_u32 v5, v19, v21, s51
    s_lshl_b32 s46, s48, 13
    s_lshl_b32 s51, s44, 10
    s_add_u32 s46, s46, s51
    s_cmp_ge_u32 s3, 4
    s_cselect_b32 s12, s82, s80
    s_cselect_b32 s13, s83, s81
    s_mov_b32 s14, 1605632
    s_mov_b32 s15, 0x00020000
    s_mul_i32 s50, s40, 28
    s_add_u32 s50, s50, s41
    s_sub_u32 s50, s50, 4
    s_lshl_b32 s50, s50, 13
    v_lshlrev_b32 v22, 7, v1
    s_cmp_eq_u32 s3, 1
    s_cbranch_scc1 L_gt_2
    s_cmp_eq_u32 s3, 0
    s_cselect_b32 s50, s50, 0x10000000
    buffer_load_dword v17, v22, s[4:7], s50 offen
    s_branch L_gt_1
L_gt_2:
    buffer_load_dword v17, v22, s[8:11], s50 offen
L_gt_1:
    s_barrier
    s_add_u32 m0, s47, 32768
    s_movk_i32 s56, 128
    buffer_load_dwordx4 v2, s[4:7], s56 offen lds
    s_add_u32 m0, s47, 33792
    s_movk_i32 s56, 128
    buffer_load_dwordx4 v3, s[4:7], s56 offen lds
    s_add_u32 m0, s47, 49152
    s_movk_i32 s56, 256
    buffer_load_dwordx4 v2, s[4:7], s56 offen lds
    s_add_u32 m0, s47, 50176
    s_movk_i32 s56, 256
    buffer_load_dwordx4 v3, s[4:7], s56 offen lds
    s_add_u32 m0, s47, 65536
    s_mov_b32 s56, 344064
    buffer_load_dwordx4 v4, s[8:11], s56 offen lds
    s_add_u32 m0, s47, 66560
    s_mov_b32 s56, 365568
    buffer_load_dwordx4 v4, s[8:11], s56 offen lds
    s_lshr_b32 s54, s41, 4
    s_lshl_b32 s62, s40, 1
    s_add_u32 s62, s62, s54
    s_and_b32 s63, s41, 15
    s_lshl_b32 s45, s42, 2
    s_add_u32 s45, s45, s44
    s_mov_b32 s20, s76
    s_mov_b32 s21, s77
    s_mov_b32 s22, 401408
    s_mov_b32 s23, 0x00020000
    s_mov_b32 s16, s84
    s_mov_b32 s17, s85
    s_mov_b32 s18, 1605632
    s_mov_b32 s19, 0x00020000
    s_mov_b32 s28, s88
    s_mov_b32 s29, s89
    s_mov_b32 s30, 1835008
    s_mov_b32 s31, 0x00020000
    s_mov_b32 s32, s90
    s_mov_b32 s33, s91
    s_mov_b32 s34, 256
    s_mov_b32 s35, 0x00020000
    s_mov_b32 s24, s92
    s_mov_b32 s25, s93
    s_mov_b32 s26, 16777216
    s_mov_b32 s27, 0x00020000
    v_lshlrev_b32 v16, 4, v1
    v_lshrrev_b32 v18, 5, v1
    v_bfe_u32 v19, v1, 4, 1
    v_bfe_u32 v20, v1, 2, 2
    v_and_b32 v21, 3, v1
    v_and_b32 v22, 31, v1
    v_lshlrev_b32 v10, 2, v22
    s_lshl_b32 s51, s44, 5
    v_add_u32 v22, s51, v22
    v_lshlrev_b32 v22, 7, v22
    v_bfe_u32 v23, v1, 1, 3
    v_xor_b32 v23, v23, v18
    v_lshl_add_u32 v6, v23, 4, v22
    v_lshl_add_u32 v22, v18, 3, v20
    v_and_b32 v23, 2, v20
    v_add_u32 v23, v23, v19
    v_lshlrev_b32 v23, 5, v23
    v_lshl_add_u32 v23, v21, 3, v23
    v_lshl_add_u32 v23, v22, 7, v23
    s_lshl_b32 s51, s48, 6
    v_xor_b32 v8, s51, v23
    v_lshl_add_u32 v9, v19, 13, v8
    v_mov_b32 v11, 0xc0135761
    s_mul_i32 s49, s45, 114688
    s_lshl_b32 s51, s43, 13
    s_add_u32 s49, s49, s51
    s_lshl_b32 s51, s48, 11
    s_add_u32 s49, s49, s51
    s_add_u32 s49, s49, 6291456
    s_waitcnt vmcnt(7) lgkmcnt(0)
    s_barrier
    v_add_u32 v254, 16384, v8
    s_sub_u32 s50, s2, 32
    s_lshl_b32 s50, s50, 13
    v_lshlrev_b32 v22, 7, v1
    s_cmp_eq_u32 s44, 2
    s_cselect_b32 s51, s50, 0x10000000
    buffer_load_dword v17, v22, s[12:15], s51 offen
    v_xor_b32 v7, 0, v6
    ds_read_b128 v[24:27], v7
    ds_read_b64_tr_b16 v[240:241], v254 offset:0
    ds_read_b64_tr_b16 v[242:243], v254 offset:512
    s_add_u32 m0, s47, 81920
    s_movk_i32 s56, 384
    buffer_load_dwordx4 v2, s[4:7], s56 offen lds
    v_xor_b32 v7, 32, v6
    ds_read_b128 v[28:31], v7
    ds_read_b64_tr_b16 v[244:245], v254 offset:2048
    ds_read_b64_tr_b16 v[246:247], v254 offset:2560
    s_add_u32 m0, s47, 82944
    s_movk_i32 s56, 384
    buffer_load_dwordx4 v3, s[4:7], s56 offen lds
    v_xor_b32 v7, 64, v6
    ds_read_b128 v[32:35], v7
    ds_read_b64_tr_b16 v[248:249], v254 offset:4096
    ds_read_b64_tr_b16 v[250:251], v254 offset:4608
    s_waitcnt lgkmcnt(6)
    v_mfma_f32_32x32x16_bf16 v[136:151], v[240:243], v[24:27], 0
    s_add_u32 m0, s47, 98304
    s_movk_i32 s56, 512
    buffer_load_dwordx4 v2, s[4:7], s56 offen lds
    v_xor_b32 v7, 96, v6
    ds_read_b128 v[36:39], v7
    ds_read_b64_tr_b16 v[240:241], v254 offset:6144
    ds_read_b64_tr_b16 v[242:243], v254 offset:6656
    s_waitcnt lgkmcnt(6)
    v_mfma_f32_32x32x16_bf16 v[136:151], v[244:247], v[28:31], v[136:151]
    s_add_u32 m0, s47, 99328
    s_movk_i32 s56, 512
    buffer_load_dwordx4 v3, s[4:7], s56 offen lds
    s_waitcnt lgkmcnt(3)
    v_mfma_f32_32x32x16_bf16 v[136:151], v[248:251], v[32:35], v[136:151]
    s_add_u32 m0, s47, 114688
    s_mov_b32 s56, 688128
    buffer_load_dwordx4 v4, s[8:11], s56 offen lds
    s_waitcnt vmcnt(10) lgkmcnt(0)
    s_barrier
    s_cmp_lg_u32 s3, 0
    s_cbranch_scc1 L_cinit_3
    v_lshlrev_b32 v18, 2, v1
    v_add_u32 v18, 155648, v18
    v_cmp_eq_u32 vcc, 1, v1
    s_nop 1
    v_cndmask_b32 v19, 0, 0, vcc
    ds_write_b32 v18, v19
L_cinit_3:
    v_xor_b32 v7, 32768, v6
    ds_read_b128 v[40:43], v7
    ds_read_b64_tr_b16 v[244:245], v254 offset:8192
    ds_read_b64_tr_b16 v[246:247], v254 offset:8704
    s_add_u32 m0, s47, 115712
    s_mov_b32 s56, 709632
    buffer_load_dwordx4 v4, s[8:11], s56 offen lds
    v_xor_b32 v7, 32800, v6
    ds_read_b128 v[44:47], v7
    ds_read_b64_tr_b16 v[248:249], v254 offset:10240
    ds_read_b64_tr_b16 v[250:251], v254 offset:10752
    v_mfma_f32_32x32x16_bf16 v[136:151], v[240:243], v[36:39], v[136:151]
    s_add_u32 m0, s47, 131072
    s_movk_i32 s56, 640
    buffer_load_dwordx4 v2, s[4:7], s56 offen lds
    v_xor_b32 v7, 32832, v6
    ds_read_b128 v[48:51], v7
    ds_read_b64_tr_b16 v[240:241], v254 offset:12288
    ds_read_b64_tr_b16 v[242:243], v254 offset:12800
    s_waitcnt lgkmcnt(6)
    v_mfma_f32_32x32x16_bf16 v[136:151], v[244:247], v[40:43], v[136:151]
    s_add_u32 m0, s47, 132096
    s_movk_i32 s56, 640
    buffer_load_dwordx4 v3, s[4:7], s56 offen lds
    v_xor_b32 v7, 32864, v6
    ds_read_b128 v[52:55], v7
    ds_read_b64_tr_b16 v[244:245], v254 offset:14336
    ds_read_b64_tr_b16 v[246:247], v254 offset:14848
    s_waitcnt lgkmcnt(6)
    v_mfma_f32_32x32x16_bf16 v[136:151], v[248:251], v[44:47], v[136:151]
    s_add_u32 m0, s46, 0
    s_mov_b32 s56, 0
    buffer_load_dwordx4 v5, s[12:15], s56 offen lds
    s_waitcnt lgkmcnt(3)
    v_mfma_f32_32x32x16_bf16 v[136:151], v[240:243], v[48:51], v[136:151]
    s_add_u32 m0, s46, 4096
    s_mov_b32 s56, 114688
    buffer_load_dwordx4 v5, s[12:15], s56 offen lds
    s_waitcnt vmcnt(11) lgkmcnt(0)
    s_barrier
    v_add_u32 v254, 65536, v8
    v_xor_b32 v7, 49152, v6
    ds_read_b128 v[56:59], v7
    ds_read_b64_tr_b16 v[248:249], v254 offset:0
    ds_read_b64_tr_b16 v[250:251], v254 offset:512
    s_add_u32 m0, s47, 16384
    s_movk_i32 s56, 768
    buffer_load_dwordx4 v2, s[4:7], s56 offen lds
    v_xor_b32 v7, 49184, v6
    ds_read_b128 v[60:63], v7
    ds_read_b64_tr_b16 v[240:241], v254 offset:2048
    ds_read_b64_tr_b16 v[242:243], v254 offset:2560
    v_mfma_f32_32x32x16_bf16 v[136:151], v[244:247], v[52:55], v[136:151]
    s_add_u32 m0, s47, 17408
    s_movk_i32 s56, 768
    buffer_load_dwordx4 v3, s[4:7], s56 offen lds
    v_xor_b32 v7, 49216, v6
    ds_read_b128 v[64:67], v7
    ds_read_b64_tr_b16 v[244:245], v254 offset:4096
    ds_read_b64_tr_b16 v[246:247], v254 offset:4608
    s_waitcnt lgkmcnt(6)
    v_mfma_f32_32x32x16_bf16 v[136:151], v[248:251], v[56:59], v[136:151]
    s_add_u32 m0, s47, 32768
    s_mov_b32 s56, 1032192
    buffer_load_dwordx4 v4, s[8:11], s56 offen lds
    v_xor_b32 v7, 49248, v6
    ds_read_b128 v[68:71], v7
    ds_read_b64_tr_b16 v[248:249], v254 offset:6144
    ds_read_b64_tr_b16 v[250:251], v254 offset:6656
    s_waitcnt lgkmcnt(6)
    v_mfma_f32_32x32x16_bf16 v[136:151], v[240:243], v[60:63], v[136:151]
    s_add_u32 m0, s47, 33792
    s_mov_b32 s56, 1053696
    buffer_load_dwordx4 v4, s[8:11], s56 offen lds
    s_waitcnt lgkmcnt(3)
    v_mfma_f32_32x32x16_bf16 v[136:151], v[244:247], v[64:67], v[136:151]
    s_waitcnt vmcnt(12) lgkmcnt(0)
    s_barrier
    v_mov_b32 v20, 0
    buffer_load_dwordx2 v[18:19], v20, s[32:35], 0 offen sc1
    v_xor_b32 v7, 81920, v6
    ds_read_b128 v[72:75], v7
    ds_read_b64_tr_b16 v[240:241], v254 offset:8192
    ds_read_b64_tr_b16 v[242:243], v254 offset:8704
    s_add_u32 m0, s46, 49152
    s_mov_b32 s56, 229376
    buffer_load_dwordx4 v5, s[12:15], s56 offen lds
    v_xor_b32 v7, 81952, v6
    ds_read_b128 v[76:79], v7
    ds_read_b64_tr_b16 v[244:245], v254 offset:10240
    ds_read_b64_tr_b16 v[246:247], v254 offset:10752
    v_mfma_f32_32x32x16_bf16 v[136:151], v[248:251], v[68:71], v[136:151]
    s_add_u32 m0, s46, 53248
    s_mov_b32 s56, 344064
    buffer_load_dwordx4 v5, s[12:15], s56 offen lds
    v_xor_b32 v7, 81984, v6
    ds_read_b128 v[80:83], v7
    ds_read_b64_tr_b16 v[248:249], v254 offset:12288
    ds_read_b64_tr_b16 v[250:251], v254 offset:12800
    s_waitcnt lgkmcnt(6)
    v_mfma_f32_32x32x16_bf16 v[136:151], v[240:243], v[72:75], v[136:151]
    v_xor_b32 v7, 82016, v6
    ds_read_b128 v[84:87], v7
    ds_read_b64_tr_b16 v[240:241], v254 offset:14336
    ds_read_b64_tr_b16 v[242:243], v254 offset:14848
    s_waitcnt lgkmcnt(6)
    v_mfma_f32_32x32x16_bf16 v[136:151], v[244:247], v[76:79], v[136:151]
    s_waitcnt lgkmcnt(3)
    v_mfma_f32_32x32x16_bf16 v[136:151], v[248:251], v[80:83], v[136:151]
    s_waitcnt vmcnt(11) lgkmcnt(0)
    s_barrier
    v_add_u32 v254, 114688, v8
    v_xor_b32 v7, 98304, v6
    ds_read_b128 v[88:91], v7
    ds_read_b64_tr_b16 v[244:245], v254 offset:0
    ds_read_b64_tr_b16 v[246:247], v254 offset:512
    s_add_u32 m0, s46, 65536
    s_mov_b32 s56, 458752
    buffer_load_dwordx4 v5, s[12:15], s56 offen lds
    v_xor_b32 v7, 98336, v6
    ds_read_b128 v[92:95], v7
    ds_read_b64_tr_b16 v[248:249], v254 offset:2048
    ds_read_b64_tr_b16 v[250:251], v254 offset:2560
    v_mfma_f32_32x32x16_bf16 v[136:151], v[240:243], v[84:87], v[136:151]
    s_add_u32 m0, s46, 69632
    s_mov_b32 s56, 573440
    buffer_load_dwordx4 v5, s[12:15], s56 offen lds
    v_xor_b32 v7, 98368, v6
    ds_read_b128 v[96:99], v7
    ds_read_b64_tr_b16 v[240:241], v254 offset:4096
    ds_read_b64_tr_b16 v[242:243], v254 offset:4608
    s_waitcnt lgkmcnt(6)
    v_mfma_f32_32x32x16_bf16 v[136:151], v[244:247], v[88:91], v[136:151]
    s_add_u32 m0, s46, 81920
    s_mov_b32 s56, 688128
    buffer_load_dwordx4 v5, s[12:15], s56 offen lds
    v_xor_b32 v7, 98400, v6
    ds_read_b128 v[100:103], v7
    ds_read_b64_tr_b16 v[244:245], v254 offset:6144
    ds_read_b64_tr_b16 v[246:247], v254 offset:6656
    s_waitcnt lgkmcnt(6)
    v_mfma_f32_32x32x16_bf16 v[136:151], v[248:251], v[92:95], v[136:151]
    s_add_u32 m0, s46, 86016
    s_mov_b32 s56, 802816
    buffer_load_dwordx4 v5, s[12:15], s56 offen lds
    s_sub_u32 s50, s2, 32
    s_lshl_b32 s50, s50, 13
    v_lshlrev_b32 v22, 7, v1
    s_cmp_eq_u32 s3, 3
    s_cselect_b32 s51, s50, 0x10000000
    buffer_load_dword v17, v22, s[16:19], s51 offen
    s_cmp_eq_u32 s3, 7
    s_cselect_b32 s51, s50, 0x10000000
    buffer_load_dword v17, v22, s[20:23], s51 offen
    s_waitcnt lgkmcnt(3)
    v_mfma_f32_32x32x16_bf16 v[136:151], v[240:243], v[96:99], v[136:151]
    s_waitcnt vmcnt(13) lgkmcnt(0)
    s_barrier
    v_xor_b32 v252, 0, v9
    v_xor_b32 v253, 32, v9
    s_waitcnt vmcnt(8)
    v_readfirstlane_b32 s60, v18
    v_readfirstlane_b32 s61, v19
    s_nop 0
    s_cmp_lg_u32 s61, 0
    s_cbranch_scc1 L_tagok_4
    s_mov_b32 s58, 0x4000
    v_mov_b32 v20, 0
L_tag_5:
    buffer_load_dwordx2 v[18:19], v20, s[32:35], 0 offen sc1
    s_waitcnt vmcnt(0)
    v_readfirstlane_b32 s60, v18
    v_readfirstlane_b32 s61, v19
    s_nop 0
    s_cmp_lg_u32 s61, 0
    s_cbranch_scc1 L_tagd_6
    s_sleep 4
    s_sub_u32 s58, s58, 1
    s_cmp_lg_u32 s58, 0
    s_cbranch_scc1 L_tag_5
L_tagd_6:
L_tagok_4:
    v_mov_b32 v12, s60
    v_mov_b32 v13, s61
    v_lshlrev_b32 v14, 3, v1
    v_xor_b32 v7, 131072, v6
    ds_read_b128 v[104:107], v7
    ds_read_b64_tr_b16 v[232:233], v252 offset:0
    ds_read_b64_tr_b16 v[234:235], v252 offset:512
    ds_read_b64_tr_b16 v[236:237], v253 offset:0
    ds_read_b64_tr_b16 v[238:239], v253 offset:512
    ds_read_b64_tr_b16 v[248:249], v254 offset:8192
    ds_read_b64_tr_b16 v[250:251], v254 offset:8704
    v_mfma_f32_32x32x16_bf16 v[136:151], v[244:247], v[100:103], v[136:151]
    v_xor_b32 v7, 131104, v6
    ds_read_b128 v[108:111], v7
    ds_read_b64_tr_b16 v[216:217], v252 offset:2048
    ds_read_b64_tr_b16 v[218:219], v252 offset:2560
    ds_read_b64_tr_b16 v[220:221], v253 offset:2048
    ds_read_b64_tr_b16 v[222:223], v253 offset:2560
    ds_read_b64_tr_b16 v[240:241], v254 offset:10240
    ds_read_b64_tr_b16 v[242:243], v254 offset:10752
    s_add_u32 m0, s46, 98304
    s_mov_b32 s56, 917504
    buffer_load_dwordx4 v5, s[12:15], s56 offen lds
    s_waitcnt lgkmcnt(11)
    v_mfma_f32_32x32x16_bf16 v[152:167], v[232:235], v[24:27], 0
    v_xor_b32 v7, 131136, v6
    ds_read_b128 v[112:115], v7
    ds_read_b64_tr_b16 v[224:225], v252 offset:4096
    ds_read_b64_tr_b16 v[226:227], v252 offset:4608
    s_add_u32 m0, s46, 102400
    s_mov_b32 s56, 1032192
    buffer_load_dwordx4 v5, s[12:15], s56 offen lds
    s_waitcnt lgkmcnt(12)
    v_mfma_f32_32x32x16_bf16 v[168:183], v[236:239], v[24:27], 0
    ds_read_b64_tr_b16 v[228:229], v253 offset:4096
    ds_read_b64_tr_b16 v[230:231], v253 offset:4608
    s_waitcnt lgkmcnt(12)
    v_mfma_f32_32x32x16_bf16 v[136:151], v[248:251], v[104:107], v[136:151]
    ds_read_b64_tr_b16 v[244:245], v254 offset:12288
    ds_read_b64_tr_b16 v[246:247], v254 offset:12800
    s_waitcnt lgkmcnt(11)
    v_mfma_f32_32x32x16_bf16 v[152:167], v[216:219], v[28:31], v[152:167]
    v_xor_b32 v7, 131168, v6
    ds_read_b128 v[116:119], v7
    ds_read_b64_tr_b16 v[232:233], v252 offset:6144
    ds_read_b64_tr_b16 v[234:235], v252 offset:6656
    s_waitcnt lgkmcnt(12)
    v_mfma_f32_32x32x16_bf16 v[168:183], v[220:223], v[28:31], v[168:183]
    ds_read_b64_tr_b16 v[236:237], v253 offset:6144
    ds_read_b64_tr_b16 v[238:239], v253 offset:6656
    s_waitcnt lgkmcnt(12)
    v_mfma_f32_32x32x16_bf16 v[136:151], v[240:243], v[108:111], v[136:151]
    ds_read_b64_tr_b16 v[248:249], v254 offset:14336
    ds_read_b64_tr_b16 v[250:251], v254 offset:14848
    s_waitcnt lgkmcnt(11)
    v_mfma_f32_32x32x16_bf16 v[152:167], v[224:227], v[32:35], v[152:167]
    s_waitcnt lgkmcnt(9)
    v_mfma_f32_32x32x16_bf16 v[168:183], v[228:231], v[32:35], v[168:183]
    s_waitcnt vmcnt(8) lgkmcnt(0)
    s_barrier
    v_xor_b32 v252, 49152, v9
    v_xor_b32 v253, 49184, v9
    v_add_u32 v254, 32768, v8
    v_mfma_f32_32x32x16_bf16 v[136:151], v[244:247], v[112:115], v[136:151]
    v_xor_b32 v7, 16384, v6
    ds_read_b128 v[120:123], v7
    ds_read_b64_tr_b16 v[216:217], v252 offset:0
    ds_read_b64_tr_b16 v[218:219], v252 offset:512
    ds_read_b64_tr_b16 v[220:221], v253 offset:0
    ds_read_b64_tr_b16 v[222:223], v253 offset:512
    ds_read_b64_tr_b16 v[240:241], v254 offset:0
    ds_read_b64_tr_b16 v[242:243], v254 offset:512
    s_add_u32 m0, s46, 0
    s_mov_b32 s56, 1146880
    buffer_load_dwordx4 v5, s[12:15], s56 offen lds
    v_mfma_f32_32x32x16_bf16 v[152:167], v[232:235], v[36:39], v[152:167]
    v_xor_b32 v7, 16416, v6
    ds_read_b128 v[124:127], v7
    ds_read_b64_tr_b16 v[224:225], v252 offset:2048
    ds_read_b64_tr_b16 v[226:227], v252 offset:2560
    s_add_u32 m0, s46, 4096
    s_mov_b32 s56, 1261568
    buffer_load_dwordx4 v5, s[12:15], s56 offen lds
    v_mfma_f32_32x32x16_bf16 v[168:183], v[236:239], v[36:39], v[168:183]
    ds_read_b64_tr_b16 v[228:229], v253 offset:2048
    ds_read_b64_tr_b16 v[230:231], v253 offset:2560
    v_mfma_f32_32x32x16_bf16 v[136:151], v[248:251], v[116:119], v[136:151]
    ds_read_b64_tr_b16 v[244:245], v254 offset:2048
    ds_read_b64_tr_b16 v[246:247], v254 offset:2560
    s_add_u32 m0, s46, 114688
    s_mov_b32 s56, 1376256
    buffer_load_dwordx4 v5, s[12:15], s56 offen lds
    s_waitcnt lgkmcnt(11)
    v_mfma_f32_32x32x16_bf16 v[152:167], v[216:219], v[40:43], v[152:167]
    v_xor_b32 v7, 16448, v6
    ds_read_b128 v[128:131], v7
    ds_read_b64_tr_b16 v[232:233], v252 offset:4096
    ds_read_b64_tr_b16 v[234:235], v252 offset:4608
    s_add_u32 m0, s46, 118784
    s_mov_b32 s56, 1490944
    buffer_load_dwordx4 v5, s[12:15], s56 offen lds
    s_waitcnt lgkmcnt(12)
    v_mfma_f32_32x32x16_bf16 v[168:183], v[220:223], v[40:43], v[168:183]
    ds_read_b64_tr_b16 v[236:237], v253 offset:4096
    ds_read_b64_tr_b16 v[238:239], v253 offset:4608
    s_waitcnt lgkmcnt(12)
    v_mfma_f32_32x32x16_bf16 v[136:151], v[240:243], v[120:123], v[136:151]
    ds_read_b64_tr_b16 v[248:249], v254 offset:4096
    ds_read_b64_tr_b16 v[250:251], v254 offset:4608
    s_add_u32 m0, s46, 131072
    s_mov_b32 s56, 128
    buffer_load_dwordx4 v5, s[12:15], s56 offen lds
    s_waitcnt lgkmcnt(11)
    v_mfma_f32_32x32x16_bf16 v[152:167], v[224:227], v[44:47], v[152:167]
    v_xor_b32 v7, 16480, v6
    ds_read_b128 v[132:135], v7
    ds_read_b64_tr_b16 v[216:217], v252 offset:6144
    ds_read_b64_tr_b16 v[218:219], v252 offset:6656
    s_waitcnt lgkmcnt(12)
    v_mfma_f32_32x32x16_bf16 v[168:183], v[228:231], v[44:47], v[168:183]
    ds_read_b64_tr_b16 v[220:221], v253 offset:6144
    ds_read_b64_tr_b16 v[222:223], v253 offset:6656
    s_add_u32 m0, s46, 135168
    s_mov_b32 s56, 114816
    buffer_load_dwordx4 v5, s[12:15], s56 offen lds
    s_waitcnt lgkmcnt(12)
    v_mfma_f32_32x32x16_bf16 v[136:151], v[244:247], v[124:127], v[136:151]
    ds_read_b64_tr_b16 v[240:241], v254 offset:6144
    ds_read_b64_tr_b16 v[242:243], v254 offset:6656
    s_waitcnt lgkmcnt(11)
    v_mfma_f32_32x32x16_bf16 v[152:167], v[232:235], v[48:51], v[152:167]
    s_waitcnt lgkmcnt(9)
    v_mfma_f32_32x32x16_bf16 v[168:183], v[236:239], v[48:51], v[168:183]
    s_waitcnt vmcnt(12) lgkmcnt(0)
    s_barrier
    v_xor_b32 v252, 65536, v9
    v_xor_b32 v253, 65568, v9
    v_mfma_f32_32x32x16_bf16 v[136:151], v[248:251], v[128:131], v[136:151]
    ds_read_b64_tr_b16 v[224:225], v252 offset:0
    ds_read_b64_tr_b16 v[226:227], v252 offset:512
    ds_read_b64_tr_b16 v[228:229], v253 offset:0
    ds_read_b64_tr_b16 v[230:231], v253 offset:512
    s_add_u32 m0, s46, 16384
    s_mov_b32 s56, 229504
    buffer_load_dwordx4 v5, s[12:15], s56 offen lds
    v_mfma_f32_32x32x16_bf16 v[152:167], v[216:219], v[52:55], v[152:167]
    ds_read_b64_tr_b16 v[232:233], v252 offset:2048
    ds_read_b64_tr_b16 v[234:235], v252 offset:2560
    s_add_u32 m0, s46, 20480
    s_mov_b32 s56, 344192
    buffer_load_dwordx4 v5, s[12:15], s56 offen lds
    v_mfma_f32_32x32x16_bf16 v[168:183], v[220:223], v[52:55], v[168:183]
    ds_read_b64_tr_b16 v[236:237], v253 offset:2048
    ds_read_b64_tr_b16 v[238:239], v253 offset:2560
    v_mfma_f32_32x32x16_bf16 v[136:151], v[240:243], v[132:135], v[136:151]
    s_add_u32 m0, s46, 32768
    s_mov_b32 s56, 458880
    buffer_load_dwordx4 v5, s[12:15], s56 offen lds
    s_waitcnt lgkmcnt(6)
    v_mfma_f32_32x32x16_bf16 v[152:167], v[224:227], v[56:59], v[152:167]
    ds_read_b64_tr_b16 v[216:217], v252 offset:4096
    ds_read_b64_tr_b16 v[218:219], v252 offset:4608
    s_add_u32 m0, s46, 36864
    s_mov_b32 s56, 573568
    buffer_load_dwordx4 v5, s[12:15], s56 offen lds
    s_sub_u32 s54, s43, 7
    s_ashr_i32 s54, s54, 31
    s_and_b32 s54, s54, 17537014
    s_xor_b32 s54, s54, 1.0
    v_mul_f32 v136, s54, v136
    v_mul_f32 v137, s54, v137
    v_mul_f32 v138, s54, v138
    v_mul_f32 v139, s54, v139
    v_mul_f32 v140, s54, v140
    v_mul_f32 v141, s54, v141
    v_mul_f32 v142, s54, v142
    v_mul_f32 v143, s54, v143
    v_mul_f32 v144, s54, v144
    v_mul_f32 v145, s54, v145
    v_mul_f32 v146, s54, v146
    v_mul_f32 v147, s54, v147
    v_mul_f32 v148, s54, v148
    v_mul_f32 v149, s54, v149
    v_mul_f32 v150, s54, v150
    v_mul_f32 v151, s54, v151
    v_cvt_pk_bf16_f32 v136, v136, v137
    v_cvt_pk_bf16_f32 v137, v138, v139
    v_cvt_pk_bf16_f32 v138, v140, v141
    v_cvt_pk_bf16_f32 v139, v142, v143
    v_cvt_pk_bf16_f32 v140, v144, v145
    v_cvt_pk_bf16_f32 v141, v146, v147
    v_cvt_pk_bf16_f32 v142, v148, v149
    v_cvt_pk_bf16_f32 v143, v150, v151
    s_lshl_b32 s53, s43, 1
    s_add_u32 s53, s53, s48
    s_lshl_b32 s53, s53, 11
    s_mul_i32 s54, s45, 57344
    s_add_u32 s53, s53, s54
    v_permlane32_swap_b32 v136, v138
    v_permlane32_swap_b32 v137, v139
    v_permlane32_swap_b32 v140, v142
    v_permlane32_swap_b32 v141, v143
    buffer_store_dwordx4 v[136:139], v16, s[24:27], s53 offen sc1
    buffer_store_dwordx4 v[140:143], v16, s[24:27], s53 offen offset:1024 sc1
    s_waitcnt lgkmcnt(6)
    v_mfma_f32_32x32x16_bf16 v[168:183], v[228:231], v[56:59], v[168:183]
    ds_read_b64_tr_b16 v[220:221], v253 offset:4096
    ds_read_b64_tr_b16 v[222:223], v253 offset:4608
    s_waitcnt lgkmcnt(6)
    v_mfma_f32_32x32x16_bf16 v[152:167], v[232:235], v[60:63], v[152:167]
    ds_read_b64_tr_b16 v[224:225], v252 offset:6144
    ds_read_b64_tr_b16 v[226:227], v252 offset:6656
    s_add_u32 m0, s46, 49152
    s_mov_b32 s56, 688256
    buffer_load_dwordx4 v5, s[12:15], s56 offen lds
    s_waitcnt lgkmcnt(6)
    v_mfma_f32_32x32x16_bf16 v[168:183], v[236:239], v[60:63], v[168:183]
    ds_read_b64_tr_b16 v[228:229], v253 offset:6144
    ds_read_b64_tr_b16 v[230:231], v253 offset:6656
    s_waitcnt vmcnt(17)
    s_barrier
    v_xor_b32 v252, 81920, v9
    v_xor_b32 v253, 81952, v9
    s_waitcnt lgkmcnt(6)
    v_mfma_f32_32x32x16_bf16 v[152:167], v[216:219], v[64:67], v[152:167]
    ds_read_b64_tr_b16 v[232:233], v252 offset:0
    ds_read_b64_tr_b16 v[234:235], v252 offset:512
    s_add_u32 m0, s46, 53248
    s_mov_b32 s56, 802944
    buffer_load_dwordx4 v5, s[12:15], s56 offen lds
    s_waitcnt lgkmcnt(6)
    v_mfma_f32_32x32x16_bf16 v[168:183], v[220:223], v[64:67], v[168:183]
    ds_read_b64_tr_b16 v[236:237], v253 offset:0
    ds_read_b64_tr_b16 v[238:239], v253 offset:512
    s_waitcnt lgkmcnt(6)
    v_mfma_f32_32x32x16_bf16 v[152:167], v[224:227], v[68:71], v[152:167]
    ds_read_b64_tr_b16 v[216:217], v252 offset:2048
    ds_read_b64_tr_b16 v[218:219], v252 offset:2560
    s_waitcnt lgkmcnt(6)
    v_mfma_f32_32x32x16_bf16 v[168:183], v[228:231], v[68:71], v[168:183]
    ds_read_b64_tr_b16 v[220:221], v253 offset:2048
    ds_read_b64_tr_b16 v[222:223], v253 offset:2560
    s_waitcnt lgkmcnt(6)
    v_mfma_f32_32x32x16_bf16 v[152:167], v[232:235], v[72:75], v[152:167]
    ds_read_b64_tr_b16 v[224:225], v252 offset:4096
    ds_read_b64_tr_b16 v[226:227], v252 offset:4608
    s_waitcnt lgkmcnt(6)
    v_mfma_f32_32x32x16_bf16 v[168:183], v[236:239], v[72:75], v[168:183]
    ds_read_b64_tr_b16 v[228:229], v253 offset:4096
    ds_read_b64_tr_b16 v[230:231], v253 offset:4608
    s_waitcnt lgkmcnt(6)
    v_mfma_f32_32x32x16_bf16 v[152:167], v[216:219], v[76:79], v[152:167]
    ds_read_b64_tr_b16 v[232:233], v252 offset:6144
    ds_read_b64_tr_b16 v[234:235], v252 offset:6656
    s_waitcnt lgkmcnt(6)
    v_mfma_f32_32x32x16_bf16 v[168:183], v[220:223], v[76:79], v[168:183]
    ds_read_b64_tr_b16 v[236:237], v253 offset:6144
    ds_read_b64_tr_b16 v[238:239], v253 offset:6656
    s_waitcnt vmcnt(2)
    s_barrier
    v_xor_b32 v252, 98304, v9
    v_xor_b32 v253, 98336, v9
    s_lshl_b32 s53, s42, 4
    s_add_u32 s53, s53, s43
    s_lshl_b32 s53, s53, 7
    s_lshl_b32 s54, s3, 24
    s_add_u32 s53, s53, s54
    s_add_u32 s53, s53, 15794176
    s_mov_b64 exec, 0xffff
    buffer_store_dwordx2 v[12:13], v14, s[24:27], s53 offen sc1
    s_mov_b64 exec, -1
    s_waitcnt lgkmcnt(6)
    v_mfma_f32_32x32x16_bf16 v[152:167], v[224:227], v[80:83], v[152:167]
    ds_read_b64_tr_b16 v[216:217], v252 offset:0
    ds_read_b64_tr_b16 v[218:219], v252 offset:512
    s_add_u32 m0, s46, 65536
    s_mov_b32 s56, 917632
    buffer_load_dwordx4 v5, s[12:15], s56 offen lds
    s_waitcnt lgkmcnt(6)
    v_mfma_f32_32x32x16_bf16 v[168:183], v[228:231], v[80:83], v[168:183]
    ds_read_b64_tr_b16 v[220:221], v253 offset:0
    ds_read_b64_tr_b16 v[222:223], v253 offset:512
    s_add_u32 m0, s46, 69632
    s_mov_b32 s56, 1032320
    buffer_load_dwordx4 v5, s[12:15], s56 offen lds
    s_waitcnt lgkmcnt(6)
    v_mfma_f32_32x32x16_bf16 v[152:167], v[232:235], v[84:87], v[152:167]
    ds_read_b64_tr_b16 v[224:225], v252 offset:2048
    ds_read_b64_tr_b16 v[226:227], v252 offset:2560
    s_waitcnt lgkmcnt(6)
    v_mfma_f32_32x32x16_bf16 v[168:183], v[236:239], v[84:87], v[168:183]
    ds_read_b64_tr_b16 v[228:229], v253 offset:2048
    ds_read_b64_tr_b16 v[230:231], v253 offset:2560
    s_waitcnt lgkmcnt(6)
    v_mfma_f32_32x32x16_bf16 v[152:167], v[216:219], v[88:91], v[152:167]
    ds_read_b64_tr_b16 v[232:233], v252 offset:4096
    ds_read_b64_tr_b16 v[234:235], v252 offset:4608
    s_waitcnt lgkmcnt(6)
    v_mfma_f32_32x32x16_bf16 v[168:183], v[220:223], v[88:91], v[168:183]
    ds_read_b64_tr_b16 v[236:237], v253 offset:4096
    ds_read_b64_tr_b16 v[238:239], v253 offset:4608
    s_waitcnt lgkmcnt(6)
    v_mfma_f32_32x32x16_bf16 v[152:167], v[224:227], v[92:95], v[152:167]
    ds_read_b64_tr_b16 v[216:217], v252 offset:6144
    ds_read_b64_tr_b16 v[218:219], v252 offset:6656
    s_waitcnt lgkmcnt(6)
    v_mfma_f32_32x32x16_bf16 v[168:183], v[228:231], v[92:95], v[168:183]
    ds_read_b64_tr_b16 v[220:221], v253 offset:6144
    ds_read_b64_tr_b16 v[222:223], v253 offset:6656
    s_waitcnt vmcnt(15)
    s_barrier
    v_xor_b32 v252, 0, v9
    v_xor_b32 v253, 32, v9
    s_waitcnt lgkmcnt(6)
    v_mfma_f32_32x32x16_bf16 v[152:167], v[232:235], v[96:99], v[152:167]
    ds_read_b64_tr_b16 v[224:225], v252 offset:0
    ds_read_b64_tr_b16 v[226:227], v252 offset:512
    s_add_u32 m0, s46, 81920
    s_mov_b32 s56, 1147008
    buffer_load_dwordx4 v5, s[12:15], s56 offen lds
    s_waitcnt lgkmcnt(6)
    v_mfma_f32_32x32x16_bf16 v[168:183], v[236:239], v[96:99], v[168:183]
    ds_read_b64_tr_b16 v[228:229], v253 offset:0
    ds_read_b64_tr_b16 v[230:231], v253 offset:512
    s_add_u32 m0, s46, 86016
    s_mov_b32 s56, 1261696
    buffer_load_dwordx4 v5, s[12:15], s56 offen lds
    s_waitcnt lgkmcnt(6)
    v_mfma_f32_32x32x16_bf16 v[152:167], v[216:219], v[100:103], v[152:167]
    ds_read_b64_tr_b16 v[232:233], v252 offset:2048
    ds_read_b64_tr_b16 v[234:235], v252 offset:2560
    s_waitcnt lgkmcnt(6)
    v_mfma_f32_32x32x16_bf16 v[168:183], v[220:223], v[100:103], v[168:183]
    ds_read_b64_tr_b16 v[236:237], v253 offset:2048
    ds_read_b64_tr_b16 v[238:239], v253 offset:2560
    s_waitcnt lgkmcnt(6)
    v_mfma_f32_32x32x16_bf16 v[152:167], v[224:227], v[104:107], v[152:167]
    ds_read_b64_tr_b16 v[216:217], v252 offset:4096
    ds_read_b64_tr_b16 v[218:219], v252 offset:4608
    s_waitcnt lgkmcnt(6)
    v_mfma_f32_32x32x16_bf16 v[168:183], v[228:231], v[104:107], v[168:183]
    ds_read_b64_tr_b16 v[220:221], v253 offset:4096
    ds_read_b64_tr_b16 v[222:223], v253 offset:4608
    s_waitcnt lgkmcnt(6)
    v_mfma_f32_32x32x16_bf16 v[152:167], v[232:235], v[108:111], v[152:167]
    ds_read_b64_tr_b16 v[224:225], v252 offset:6144
    ds_read_b64_tr_b16 v[226:227], v252 offset:6656
    s_waitcnt lgkmcnt(6)
    v_mfma_f32_32x32x16_bf16 v[168:183], v[236:239], v[108:111], v[168:183]
    ds_read_b64_tr_b16 v[228:229], v253 offset:6144
    ds_read_b64_tr_b16 v[230:231], v253 offset:6656
    s_waitcnt vmcnt(11)
    s_barrier
    v_xor_b32 v252, 114688, v9
    v_xor_b32 v253, 114720, v9
    s_waitcnt lgkmcnt(6)
    v_mfma_f32_32x32x16_bf16 v[152:167], v[216:219], v[112:115], v[152:167]
    ds_read_b64_tr_b16 v[232:233], v252 offset:0
    ds_read_b64_tr_b16 v[234:235], v252 offset:512
    s_add_u32 m0, s46, 98304
    s_mov_b32 s56, 1376384
    buffer_load_dwordx4 v5, s[12:15], s56 offen lds
    s_waitcnt lgkmcnt(6)
    v_mfma_f32_32x32x16_bf16 v[168:183], v[220:223], v[112:115], v[168:183]
    ds_read_b64_tr_b16 v[236:237], v253 offset:0
    ds_read_b64_tr_b16 v[238:239], v253 offset:512
    s_add_u32 m0, s46, 102400
    s_mov_b32 s56, 1491072
    buffer_load_dwordx4 v5, s[12:15], s56 offen lds
    s_waitcnt lgkmcnt(6)
    v_mfma_f32_32x32x16_bf16 v[152:167], v[224:227], v[116:119], v[152:167]
    ds_read_b64_tr_b16 v[216:217], v252 offset:2048
    ds_read_b64_tr_b16 v[218:219], v252 offset:2560
    s_waitcnt lgkmcnt(6)
    v_mfma_f32_32x32x16_bf16 v[168:183], v[228:231], v[116:119], v[168:183]
    ds_read_b64_tr_b16 v[220:221], v253 offset:2048
    ds_read_b64_tr_b16 v[222:223], v253 offset:2560
    s_waitcnt lgkmcnt(6)
    v_mfma_f32_32x32x16_bf16 v[152:167], v[232:235], v[120:123], v[152:167]
    ds_read_b64_tr_b16 v[224:225], v252 offset:4096
    ds_read_b64_tr_b16 v[226:227], v252 offset:4608
    s_waitcnt lgkmcnt(6)
    v_mfma_f32_32x32x16_bf16 v[168:183], v[236:239], v[120:123], v[168:183]
    ds_read_b64_tr_b16 v[228:229], v253 offset:4096
    ds_read_b64_tr_b16 v[230:231], v253 offset:4608
    s_waitcnt lgkmcnt(6)
    v_mfma_f32_32x32x16_bf16 v[152:167], v[216:219], v[124:127], v[152:167]
    ds_read_b64_tr_b16 v[232:233], v252 offset:6144
    ds_read_b64_tr_b16 v[234:235], v252 offset:6656
    s_waitcnt lgkmcnt(6)
    v_mfma_f32_32x32x16_bf16 v[168:183], v[220:223], v[124:127], v[168:183]
    ds_read_b64_tr_b16 v[236:237], v253 offset:6144
    ds_read_b64_tr_b16 v[238:239], v253 offset:6656
    s_cmp_ge_u32 s3, 4
    s_cbranch_scc1 L_G
    s_mul_i32 s71, s62, 7
    s_lshr_b32 s71, s71, 1
    s_lshr_b32 s50, s71, 3
    s_add_u32 s51, s71, 3
    s_lshr_b32 s51, s51, 3
    s_lshl_b32 s51, s51, 8
    s_or_b32 s56, s50, s51
    s_lshr_b32 s50, s62, 3
    s_mul_i32 s50, s50, 0x01010000
    s_or_b32 s98, s50, s56
    s_add_u32 s98, s98, 0x0e0e0707
    s_mul_i32 s56, s56, 0x10001
    v_bfe_u32 v2, v1, 2, 2
    v_lshlrev_b32 v2, 3, v2
    v_lshrrev_b32 v3, v2, s98
    v_lshrrev_b32 v2, v2, s56
    v_and_b32 v4, 3, v1
    s_lshl_b32 s50, s3, 2
    v_add_u32 v4, s50, v4
    v_mov_b32 v5, s63
    v_cmp_le_u32 vcc, 32, v1
    s_nop 1
    v_cndmask_b32 v2, v3, v2, vcc
    v_cndmask_b32 v4, v4, v5, vcc
    v_and_b32 v2, 0xff, v2
    v_lshl_add_u32 v2, v4, 4, v2
    v_lshlrev_b32 v2, 7, v2
    v_add_u32 v2, 15794176, v2
    s_lshl_b32 s50, s63, 2
    s_add_u32 s99, s50, s3
    v_and_b32 v5, 31, v1
    v_cmp_eq_u32 vcc, 28, v5
    v_mov_b32 v4, 0x3f803f80
    s_nop 0
    v_cndmask_b32 v4, 0, v4, vcc
    v_lshlrev_b32 v5, 2, v5
    s_mov_b32 s66, 0x0fffffff
    s_mov_b32 s67, 0x0fffffff
    s_lshl_b32 s51, s71, 9
    s_mul_i32 s68, s3, 917504
    s_add_u32 s68, s68, s51
    s_add_u32 s68, s68, 28672
    s_mul_i32 s69, s62, 448
    s_mul_i32 s52, s3, 458752
    s_add_u32 s69, s69, s52
    s_add_u32 s69, s69, 4194304
    v_lshrrev_b32 v3, 5, v1
    v_mul_u32_u24 v3, 6656, v3
    v_add_u32 v3, v3, v16
    v_add_u32 v23, 14336, v3
    s_mul_i32 s47, s63, 229376
    s_add_u32 s47, s47, s51
    s_lshl_b32 s50, s99, 4
    s_add_u32 s50, s50, s62
    s_lshl_b32 s46, s50, 11
    s_add_u32 s46, s46, 13631488
    s_add_u32 s50, s3, 1
    s_and_b32 s50, s50, 3
    s_mul_i32 s50, s50, 12288
    s_add_u32 s50, s50, 49152
    v_add_u32 v6, s50, v16
    s_add_u32 s50, s3, 2
    s_and_b32 s50, s50, 3
    s_mul_i32 s50, s50, 12288
    s_add_u32 s50, s50, 53248
    v_add_u32 v7, s50, v16
    s_add_u32 s50, s3, 3
    s_and_b32 s50, s50, 3
    s_mul_i32 s50, s50, 12288
    s_add_u32 s50, s50, 57344
    v_add_u32 v8, s50, v16
    s_add_u32 s50, s3, 4
    s_and_b32 s50, s50, 3
    s_mul_i32 s50, s50, 12288
    s_add_u32 s50, s50, 49152
    v_add_u32 v15, s50, v16
    s_waitcnt lgkmcnt(6)
    v_mfma_f32_32x32x16_bf16 v[152:167], v[224:227], v[128:131], v[152:167]
    s_waitcnt lgkmcnt(4)
    v_mfma_f32_32x32x16_bf16 v[168:183], v[228:231], v[128:131], v[168:183]
    s_waitcnt lgkmcnt(2)
    v_mfma_f32_32x32x16_bf16 v[152:167], v[232:235], v[132:135], v[152:167]
    s_waitcnt lgkmcnt(0)
    v_mfma_f32_32x32x16_bf16 v[168:183], v[236:239], v[132:135], v[168:183]
    v_mov_b32 v252, 155652
    v_mov_b32 v253, 1
    s_waitcnt lgkmcnt(0)
    s_mov_b64 exec, 1
    ds_add_u32 v252, v253
    s_mov_b64 exec, -1
    s_mov_b32 exec_lo, 0x00ff00ff
    buffer_load_dwordx2 v[18:19], v2, s[24:27], 0 offen sc1
    s_mov_b32 exec_lo, -1
    v_mov_b32 v24, -1
    v_mov_b32 v25, -1
    v_mov_b32 v26, -1
    v_mov_b32 v27, -1
    buffer_store_dwordx4 v[24:27], v16, s[24:27], s46 offen offset:0 sc1
    buffer_store_dwordx4 v[24:27], v16, s[24:27], s46 offen offset:1024 sc1
    s_nop 1
    v_mov_b32 v24, v4
    v_mov_b32 v25, v4
    v_mov_b32 v26, v4
    v_mov_b32 v27, v4
    v_mov_b32 v28, v4
    v_mov_b32 v29, v4
    v_mov_b32 v30, v4
    v_mov_b32 v31, v4
    v_mov_b32 v32, v4
    v_mov_b32 v33, v4
    v_mov_b32 v34, v4
    v_mov_b32 v35, v4
    v_mov_b32 v36, v4
    v_mov_b32 v37, v4
    v_mov_b32 v38, v4
    v_mov_b32 v39, v4
    v_mov_b32 v40, v4
    v_mov_b32 v41, v4
    v_mov_b32 v42, v4
    v_mov_b32 v43, v4
    v_mov_b32 v44, v4
    v_mov_b32 v45, v4
    v_mov_b32 v46, v4
    v_mov_b32 v47, v4
    v_mov_b32 v48, v4
    v_mov_b32 v49, v4
    v_mov_b32 v50, v4
    v_mov_b32 v51, v4
    v_mov_b32 v52, v4
    v_mov_b32 v53, v4
    v_mov_b32 v54, v4
    v_mov_b32 v55, v4
    v_mul_f32 v240, v152, v152
    v_mul_f32 v241, v153, v153
    v_mul_f32 v242, v154, v154
    v_mul_f32 v243, v155, v155
    v_mul_f32 v244, v156, v156
    v_mul_f32 v245, v157, v157
    v_mul_f32 v246, v158, v158
    v_mul_f32 v247, v159, v159
    v_fmamk_f32 v240, v240, 0xbdd2d3e8, v11
    v_fmamk_f32 v241, v241, 0xbdd2d3e8, v11
    v_fmamk_f32 v242, v242, 0xbdd2d3e8, v11
    v_fmamk_f32 v243, v243, 0xbdd2d3e8, v11
    v_fmamk_f32 v244, v244, 0xbdd2d3e8, v11
    v_fmamk_f32 v245, v245, 0xbdd2d3e8, v11
    v_fmamk_f32 v246, v246, 0xbdd2d3e8, v11
    v_fmamk_f32 v247, v247, 0xbdd2d3e8, v11
    v_mul_f32 v240, v240, v152
    v_mul_f32 v241, v241, v153
    v_mul_f32 v242, v242, v154
    v_mul_f32 v243, v243, v155
    v_mul_f32 v244, v244, v156
    v_mul_f32 v245, v245, v157
    v_mul_f32 v246, v246, v158
    v_mul_f32 v247, v247, v159
    v_exp_f32 v240, v240
    v_mul_f32 v152, v152, v160
    v_exp_f32 v241, v241
    v_mul_f32 v153, v153, v161
    v_exp_f32 v242, v242
    v_mul_f32 v154, v154, v162
    v_exp_f32 v243, v243
    v_mul_f32 v155, v155, v163
    v_exp_f32 v244, v244
    v_mul_f32 v156, v156, v164
    v_exp_f32 v245, v245
    v_mul_f32 v157, v157, v165
    v_exp_f32 v246, v246
    v_mul_f32 v158, v158, v166
    v_exp_f32 v247, v247
    v_mul_f32 v159, v159, v167
    v_add_f32 v240, 1.0, v240
    v_add_f32 v241, 1.0, v241
    v_add_f32 v242, 1.0, v242
    v_add_f32 v243, 1.0, v243
    v_add_f32 v244, 1.0, v244
    v_add_f32 v245, 1.0, v245
    v_add_f32 v246, 1.0, v246
    v_add_f32 v247, 1.0, v247
    v_rcp_f32 v240, v240
    v_rcp_f32 v241, v241
    v_rcp_f32 v242, v242
    v_rcp_f32 v243, v243
    v_rcp_f32 v244, v244
    v_rcp_f32 v245, v245
    v_rcp_f32 v246, v246
    v_rcp_f32 v247, v247
    v_mul_f32 v152, v152, v240
    v_mul_f32 v153, v153, v241
    v_mul_f32 v154, v154, v242
    v_mul_f32 v155, v155, v243
    v_mul_f32 v156, v156, v244
    v_mul_f32 v157, v157, v245
    v_mul_f32 v158, v158, v246
    v_mul_f32 v159, v159, v247
    v_cvt_pk_bf16_f32 v160, v152, v153
    v_cvt_pk_bf16_f32 v161, v154, v155
    v_cvt_pk_bf16_f32 v162, v156, v157
    v_cvt_pk_bf16_f32 v163, v158, v159
    s_add_u32 s57, s49, 0
    buffer_store_dwordx4 v[160:163], v16, s[24:27], s57 offen sc1
    s_waitcnt vmcnt(3)
    s_barrier
    v_cmp_ne_u64 vcc, s[60:61], v[18:19]
    s_nop 0
    s_and_b32 vcc_lo, vcc_lo, 0x00ff00ff
    s_cmp_eq_u64 vcc, 0
    s_cselect_b32 s64, 1, 0
    v_mul_f32 v240, v168, v168
    v_mul_f32 v241, v169, v169
    v_mul_f32 v242, v170, v170
    v_mul_f32 v243, v171, v171
    s_cmp_eq_u32 s64, 0
    s_cbranch_scc1 L_gl_7
    s_add_u32 s50, s3, 1
    s_and_b32 s50, s50, 3
    s_mul_i32 s50, s50, 57344
    s_add_u32 s50, s50, s47
    buffer_load_dwordx4 v[56:59], v16, s[24:27], s50 offen offset:0 sc1
L_gl_7:
    v_mul_f32 v244, v172, v172
    v_mul_f32 v245, v173, v173
    v_mul_f32 v246, v174, v174
    v_mul_f32 v247, v175, v175
    s_cmp_eq_u32 s64, 0
    s_cbranch_scc1 L_gl_8
    s_add_u32 s50, s3, 1
    s_and_b32 s50, s50, 3
    s_mul_i32 s50, s50, 57344
    s_add_u32 s50, s50, s47
    buffer_load_dwordx4 v[60:63], v16, s[24:27], s50 offen offset:1024 sc1
L_gl_8:
    v_fmamk_f32 v240, v240, 0xbdd2d3e8, v11
    v_fmamk_f32 v241, v241, 0xbdd2d3e8, v11
    v_fmamk_f32 v242, v242, 0xbdd2d3e8, v11
    v_fmamk_f32 v243, v243, 0xbdd2d3e8, v11
    s_cmp_eq_u32 s64, 0
    s_cbranch_scc1 L_gl_9
    s_add_u32 s50, s3, 2
    s_and_b32 s50, s50, 3
    s_mul_i32 s50, s50, 57344
    s_add_u32 s50, s50, s47
    buffer_load_dwordx4 v[64:67], v16, s[24:27], s50 offen offset:0 sc1
L_gl_9:
    v_fmamk_f32 v244, v244, 0xbdd2d3e8, v11
    v_fmamk_f32 v245, v245, 0xbdd2d3e8, v11
    v_fmamk_f32 v246, v246, 0xbdd2d3e8, v11
    v_fmamk_f32 v247, v247, 0xbdd2d3e8, v11
    s_cmp_eq_u32 s64, 0
    s_cbranch_scc1 L_gl_10
    s_add_u32 s50, s3, 2
    s_and_b32 s50, s50, 3
    s_mul_i32 s50, s50, 57344
    s_add_u32 s50, s50, s47
    buffer_load_dwordx4 v[68:71], v16, s[24:27], s50 offen offset:1024 sc1
L_gl_10:
    v_mul_f32 v240, v240, v168
    v_mul_f32 v241, v241, v169
    v_mul_f32 v242, v242, v170
    v_mul_f32 v243, v243, v171
    s_cmp_eq_u32 s64, 0
    s_cbranch_scc1 L_gl_11
    s_add_u32 s50, s3, 3
    s_and_b32 s50, s50, 3
    s_mul_i32 s50, s50, 57344
    s_add_u32 s50, s50, s47
    buffer_load_dwordx4 v[72:75], v16, s[24:27], s50 offen offset:0 sc1
L_gl_11:
    v_mul_f32 v244, v244, v172
    v_mul_f32 v245, v245, v173
    v_mul_f32 v246, v246, v174
    v_mul_f32 v247, v247, v175
    s_cmp_eq_u32 s64, 0
    s_cbranch_scc1 L_gl_12
    s_add_u32 s50, s3, 3
    s_and_b32 s50, s50, 3
    s_mul_i32 s50, s50, 57344
    s_add_u32 s50, s50, s47
    buffer_load_dwordx4 v[76:79], v16, s[24:27], s50 offen offset:1024 sc1
L_gl_12:
    v_exp_f32 v240, v240
    v_mul_f32 v168, v168, v176
    v_exp_f32 v241, v241
    v_mul_f32 v169, v169, v177
    s_cmp_eq_u32 s64, 0
    s_cbranch_scc1 L_gl_13
    s_add_u32 s50, s3, 4
    s_and_b32 s50, s50, 3
    s_mul_i32 s50, s50, 57344
    s_add_u32 s50, s50, s47
    buffer_load_dwordx4 v[80:83], v16, s[24:27], s50 offen offset:0 sc1
L_gl_13:
    v_exp_f32 v242, v242
    v_mul_f32 v170, v170, v178
    v_exp_f32 v243, v243
    v_mul_f32 v171, v171, v179
    s_cmp_eq_u32 s64, 0
    s_cbranch_scc1 L_gl_14
    s_add_u32 s50, s3, 4
    s_and_b32 s50, s50, 3
    s_mul_i32 s50, s50, 57344
    s_add_u32 s50, s50, s47
    buffer_load_dwordx4 v[84:87], v16, s[24:27], s50 offen offset:1024 sc1
L_gl_14:
    v_exp_f32 v244, v244
    v_mul_f32 v172, v172, v180
    v_exp_f32 v245, v245
    v_mul_f32 v173, v173, v181
    s_cmp_eq_u32 s64, 0
    s_cbranch_scc1 L_gl_15
    buffer_load_dwordx4 v[136:139], v16, s[24:27], s68 offen offset:0 sc1
L_gl_15:
    v_exp_f32 v246, v246
    v_mul_f32 v174, v174, v182
    v_exp_f32 v247, v247
    v_mul_f32 v175, v175, v183
    s_cmp_eq_u32 s64, 0
    s_cbranch_scc1 L_gl_16
    buffer_load_dwordx4 v[140:143], v16, s[24:27], s68 offen offset:1024 sc1
    s_add_u32 s68, s68, 57344
L_gl_16:
    v_add_f32 v240, 1.0, v240
    v_add_f32 v241, 1.0, v241
    v_add_f32 v242, 1.0, v242
    v_add_f32 v243, 1.0, v243
    s_cmp_eq_u32 s64, 0
    s_cbranch_scc1 L_gl_17
    buffer_load_dwordx4 v[144:147], v16, s[24:27], s68 offen offset:0 sc1
L_gl_17:
    v_add_f32 v244, 1.0, v244
    v_add_f32 v245, 1.0, v245
    v_add_f32 v246, 1.0, v246
    v_add_f32 v247, 1.0, v247
    s_cmp_eq_u32 s64, 0
    s_cbranch_scc1 L_gl_18
    buffer_load_dwordx4 v[148:151], v16, s[24:27], s68 offen offset:1024 sc1
    s_add_u32 s68, s68, 57344
L_gl_18:
    v_rcp_f32 v240, v240
    v_rcp_f32 v241, v241
    v_rcp_f32 v242, v242
    v_rcp_f32 v243, v243
    s_cmp_eq_u32 s64, 0
    s_cbranch_scc1 L_gl_19
    buffer_load_dwordx4 v[88:91], v16, s[24:27], s68 offen offset:0 sc1
L_gl_19:
    v_rcp_f32 v244, v244
    v_rcp_f32 v245, v245
    v_rcp_f32 v246, v246
    v_rcp_f32 v247, v247
    s_cmp_eq_u32 s64, 0
    s_cbranch_scc1 L_gl_20
    buffer_load_dwordx4 v[92:95], v16, s[24:27], s68 offen offset:1024 sc1
    s_add_u32 s68, s68, 57344
L_gl_20:
    v_mul_f32 v168, v168, v240
    v_mul_f32 v169, v169, v241
    v_mul_f32 v170, v170, v242
    v_mul_f32 v171, v171, v243
    s_cmp_eq_u32 s64, 0
    s_cbranch_scc1 L_gl_21
    buffer_load_dwordx4 v[96:99], v16, s[24:27], s68 offen offset:0 sc1
L_gl_21:
    v_mul_f32 v172, v172, v244
    v_mul_f32 v173, v173, v245
    v_mul_f32 v174, v174, v246
    v_mul_f32 v175, v175, v247
    s_cmp_eq_u32 s64, 0
    s_cbranch_scc1 L_gl_22
    buffer_load_dwordx4 v[100:103], v16, s[24:27], s68 offen offset:1024 sc1
    s_add_u32 s68, s68, 57344
L_gl_22:
    v_cvt_pk_bf16_f32 v176, v168, v169
    v_cvt_pk_bf16_f32 v177, v170, v171
    v_cvt_pk_bf16_f32 v178, v172, v173
    v_cvt_pk_bf16_f32 v179, v174, v175
    s_add_u32 s57, s49, 1024
    buffer_store_dwordx4 v[176:179], v16, s[24:27], s57 offen sc1
    s_lshl_b32 s59, s45, 4
    s_add_u32 s59, s59, s43
    s_lshl_b32 s59, s59, 8
    s_add_u32 s59, s59, 15859712
L_attn_late:
    s_mov_b32 s58, 0x4000
L_poll_23:
    buffer_load_dwordx2 v[18:19], v2, s[24:27], 0 offen sc1
    s_waitcnt vmcnt(0)
    v_cmp_ne_u64 vcc, s[60:61], v[18:19]
    s_nop 4
    s_cbranch_vccz L_polld_24
    s_sleep 2
    s_sub_u32 s58, s58, 1
    s_cmp_lg_u32 s58, 0
    s_cbranch_scc1 L_poll_23
L_polld_24:
    s_mov_b64 exec, s[66:67]
    buffer_load_dwordx4 v[24:27], v3, s[24:27], s69 offen sc1
    buffer_load_dwordx4 v[28:31], v23, s[24:27], s69 offen sc1
    s_mov_b64 exec, -1
    s_add_u32 s69, s69, 28672
    s_mov_b64 exec, s[66:67]
    buffer_load_dwordx4 v[32:35], v3, s[24:27], s69 offen sc1
    buffer_load_dwordx4 v[36:39], v23, s[24:27], s69 offen sc1
    s_mov_b64 exec, -1
    s_add_u32 s69, s69, 28672
    s_mov_b64 exec, s[66:67]
    buffer_load_dwordx4 v[40:43], v3, s[24:27], s69 offen sc1
    buffer_load_dwordx4 v[44:47], v23, s[24:27], s69 offen sc1
    s_mov_b64 exec, -1
    s_add_u32 s69, s69, 28672
    s_cmp_eq_u32 s64, 1
    s_cbranch_scc1 L_qk_25
    s_add_u32 s50, s3, 1
    s_and_b32 s50, s50, 3
    s_mul_i32 s50, s50, 57344
    s_add_u32 s50, s50, s47
    buffer_load_dwordx4 v[56:59], v16, s[24:27], s50 offen offset:0 sc1
    s_add_u32 s50, s3, 1
    s_and_b32 s50, s50, 3
    s_mul_i32 s50, s50, 57344
    s_add_u32 s50, s50, s47
    buffer_load_dwordx4 v[60:63], v16, s[24:27], s50 offen offset:1024 sc1
    s_add_u32 s50, s3, 2
    s_and_b32 s50, s50, 3
    s_mul_i32 s50, s50, 57344
    s_add_u32 s50, s50, s47
    buffer_load_dwordx4 v[64:67], v16, s[24:27], s50 offen offset:0 sc1
    s_add_u32 s50, s3, 2
    s_and_b32 s50, s50, 3
    s_mul_i32 s50, s50, 57344
    s_add_u32 s50, s50, s47
    buffer_load_dwordx4 v[68:71], v16, s[24:27], s50 offen offset:1024 sc1
    s_add_u32 s50, s3, 3
    s_and_b32 s50, s50, 3
    s_mul_i32 s50, s50, 57344
    s_add_u32 s50, s50, s47
    buffer_load_dwordx4 v[72:75], v16, s[24:27], s50 offen offset:0 sc1
    s_add_u32 s50, s3, 3
    s_and_b32 s50, s50, 3
    s_mul_i32 s50, s50, 57344
    s_add_u32 s50, s50, s47
    buffer_load_dwordx4 v[76:79], v16, s[24:27], s50 offen offset:1024 sc1
    s_add_u32 s50, s3, 4
    s_and_b32 s50, s50, 3
    s_mul_i32 s50, s50, 57344
    s_add_u32 s50, s50, s47
    buffer_load_dwordx4 v[80:83], v16, s[24:27], s50 offen offset:0 sc1
    s_add_u32 s50, s3, 4
    s_and_b32 s50, s50, 3
    s_mul_i32 s50, s50, 57344
    s_add_u32 s50, s50, s47
    buffer_load_dwordx4 v[84:87], v16, s[24:27], s50 offen offset:1024 sc1
    buffer_load_dwordx4 v[136:139], v16, s[24:27], s68 offen offset:0 sc1
    buffer_load_dwordx4 v[140:143], v16, s[24:27], s68 offen offset:1024 sc1
    s_add_u32 s68, s68, 57344
    buffer_load_dwordx4 v[144:147], v16, s[24:27], s68 offen offset:0 sc1
    buffer_load_dwordx4 v[148:151], v16, s[24:27], s68 offen offset:1024 sc1
    s_add_u32 s68, s68, 57344
    buffer_load_dwordx4 v[88:91], v16, s[24:27], s68 offen offset:0 sc1
    buffer_load_dwordx4 v[92:95], v16, s[24:27], s68 offen offset:1024 sc1
    s_add_u32 s68, s68, 57344
    buffer_load_dwordx4 v[96:99], v16, s[24:27], s68 offen offset:0 sc1
    buffer_load_dwordx4 v[100:103], v16, s[24:27], s68 offen offset:1024 sc1
    s_add_u32 s68, s68, 57344
L_qk_25:
    s_mov_b64 exec, 0xffff
    buffer_store_dwordx2 v[12:13], v14, s[24:27], s59 offen sc1
    s_mov_b64 exec, -1
    s_sub_u32 s53, s46, 13631488
    s_lshr_b32 s53, s53, 4
    s_add_u32 s53, s53, 16121856
    s_mov_b64 exec, 0xffff
    buffer_store_dwordx2 v[12:13], v14, s[24:27], s53 offen sc1
    s_mov_b64 exec, -1
L_attn:
    s_setprio 2
    v_mov_b32 v252, 0
    v_mov_b32 v253, 0
    v_mov_b32 v254, 0
    v_mov_b32 v255, 0
    v_mov_b32 v10, 155648
    v_mov_b32 v11, 1
    v_mov_b32 v18, 0
    v_mov_b32 v19, 0
    s_lshl_b32 s50, s99, 12
    s_add_u32 s50, s50, 15863296
    v_mov_b32 v2, s50
    s_lshl_b32 s47, s99, 7
    s_add_u32 s47, s47, 15728640
    s_mov_b32 s64, 0
    s_lshl_b32 s50, s3, 2
    s_add_u32 s50, s50, 155712
    v_mov_b32 v20, s50
    v_mfma_f32_32x32x16_bf16 v[152:167], v[252:255], v[252:255], 0
    v_mfma_f32_32x32x16_bf16 v[168:183], v[252:255], v[252:255], 0
    v_mfma_f32_32x32x16_bf16 v[216:231], v[252:255], v[252:255], 0
    v_mfma_f32_32x32x16_bf16 v[184:199], v[252:255], v[252:255], 0
    s_waitcnt vmcnt(2)
    s_and_b32 s50, s62, 1
    s_cmp_eq_u32 s50, 0
    s_cbranch_scc1 L_qeven_26
    s_mov_b32 exec_hi, 0
    v_mov_b32 v56, 0
    v_mov_b32 v57, 0
    v_mov_b32 v64, 0
    v_mov_b32 v65, 0
    v_mov_b32 v72, 0
    v_mov_b32 v73, 0
    v_mov_b32 v80, 0
    v_mov_b32 v81, 0
    s_branch L_qdone_27
L_qeven_26:
    s_mov_b32 exec_lo, 0
    v_mov_b32 v62, 0
    v_mov_b32 v63, 0
    v_mov_b32 v70, 0
    v_mov_b32 v71, 0
    v_mov_b32 v78, 0
    v_mov_b32 v79, 0
    v_mov_b32 v86, 0
    v_mov_b32 v87, 0
L_qdone_27:
    s_mov_b64 exec, -1
    s_nop 1
    v_mfma_f32_32x32x16_bf16 v[104:119], v[136:139], v[56:59], 0
    v_mfma_f32_32x32x16_bf16 v[104:119], v[140:143], v[60:63], v[104:119]
    s_mov_b32 s70, 0
    s_nop 7
    s_nop 2
L_attn_loop:
    v_mfma_f32_32x32x16_bf16 v[120:135], v[136:139], v[64:67], 0
    v_exp_f32 v104, v104
    v_exp_f32 v105, v105
    v_exp_f32 v106, v106
    v_mfma_f32_32x32x16_bf16 v[120:135], v[140:143], v[68:71], v[120:135]
    v_exp_f32 v107, v107
    v_exp_f32 v108, v108
    v_exp_f32 v109, v109
    v_exp_f32 v110, v110
    v_exp_f32 v111, v111
    v_cvt_pk_bf16_f32 v248, v104, v105
    v_cvt_pk_bf16_f32 v249, v106, v107
    v_cvt_pk_bf16_f32 v250, v108, v109
    v_cvt_pk_bf16_f32 v251, v110, v111
    v_mfma_f32_32x32x16_bf16 v[184:199], v[52:55], v[252:255], v[184:199]
    v_exp_f32 v112, v112
    v_exp_f32 v113, v113
    v_exp_f32 v114, v114
    s_waitcnt vmcnt(10)
    v_mfma_f32_32x32x16_bf16 v[152:167], v[24:27], v[248:251], v[152:167]
    v_exp_f32 v115, v115
    v_exp_f32 v116, v116
    v_exp_f32 v117, v117
    s_mov_b64 exec, s[66:67]
    buffer_load_dwordx4 v[48:51], v3, s[24:27], s69 offen sc1
    buffer_load_dwordx4 v[52:55], v23, s[24:27], s69 offen sc1
    s_mov_b64 exec, -1
    s_add_u32 s69, s69, 28672
    v_exp_f32 v118, v118
    v_exp_f32 v119, v119
    v_cvt_pk_bf16_f32 v252, v112, v113
    v_cvt_pk_bf16_f32 v253, v114, v115
    v_cvt_pk_bf16_f32 v254, v116, v117
    v_cvt_pk_bf16_f32 v255, v118, v119
    v_mfma_f32_32x32x16_bf16 v[104:119], v[136:139], v[72:75], 0
    v_exp_f32 v120, v120
    v_exp_f32 v121, v121
    v_exp_f32 v122, v122
    v_mfma_f32_32x32x16_bf16 v[104:119], v[140:143], v[76:79], v[104:119]
    v_exp_f32 v123, v123
    v_exp_f32 v124, v124
    v_exp_f32 v125, v125
    v_exp_f32 v126, v126
    v_exp_f32 v127, v127
    v_cvt_pk_bf16_f32 v248, v120, v121
    v_cvt_pk_bf16_f32 v249, v122, v123
    v_cvt_pk_bf16_f32 v250, v124, v125
    v_cvt_pk_bf16_f32 v251, v126, v127
    v_mfma_f32_32x32x16_bf16 v[152:167], v[28:31], v[252:255], v[152:167]
    v_exp_f32 v128, v128
    v_exp_f32 v129, v129
    v_exp_f32 v130, v130
    v_mfma_f32_32x32x16_bf16 v[168:183], v[24:27], v[248:251], v[168:183]
    v_exp_f32 v131, v131
    v_exp_f32 v132, v132
    v_exp_f32 v133, v133
    v_exp_f32 v134, v134
    v_exp_f32 v135, v135
    v_cvt_pk_bf16_f32 v252, v128, v129
    v_cvt_pk_bf16_f32 v253, v130, v131
    v_cvt_pk_bf16_f32 v254, v132, v133
    v_cvt_pk_bf16_f32 v255, v134, v135
    v_mfma_f32_32x32x16_bf16 v[120:135], v[136:139], v[80:83], 0
    v_exp_f32 v104, v104
    v_exp_f32 v105, v105
    v_exp_f32 v106, v106
    v_mfma_f32_32x32x16_bf16 v[120:135], v[140:143], v[84:87], v[120:135]
    v_exp_f32 v107, v107
    v_exp_f32 v108, v108
    v_exp_f32 v109, v109
    v_exp_f32 v110, v110
    v_exp_f32 v111, v111
    v_cvt_pk_bf16_f32 v248, v104, v105
    v_cvt_pk_bf16_f32 v249, v106, v107
    v_cvt_pk_bf16_f32 v250, v108, v109
    v_cvt_pk_bf16_f32 v251, v110, v111
    v_mfma_f32_32x32x16_bf16 v[168:183], v[28:31], v[252:255], v[168:183]
    v_exp_f32 v112, v112
    v_exp_f32 v113, v113
    v_exp_f32 v114, v114
    v_mfma_f32_32x32x16_bf16 v[216:231], v[24:27], v[248:251], v[216:231]
    v_exp_f32 v115, v115
    v_exp_f32 v116, v116
    v_exp_f32 v117, v117
    v_exp_f32 v118, v118
    v_exp_f32 v119, v119
    v_cvt_pk_bf16_f32 v252, v112, v113
    v_cvt_pk_bf16_f32 v253, v114, v115
    v_cvt_pk_bf16_f32 v254, v116, v117
    v_cvt_pk_bf16_f32 v255, v118, v119
    s_waitcnt vmcnt(10)
    v_mfma_f32_32x32x16_bf16 v[104:119], v[144:147], v[56:59], 0
    v_exp_f32 v120, v120
    v_exp_f32 v121, v121
    v_exp_f32 v122, v122
    v_mfma_f32_32x32x16_bf16 v[104:119], v[148:151], v[60:63], v[104:119]
    v_exp_f32 v123, v123
    v_exp_f32 v124, v124
    v_exp_f32 v125, v125
    s_cmp_eq_u32 s70, 3
    s_cselect_b32 s68, 16777216, s68
    s_cselect_b32 s69, 16777216, s69
    buffer_load_dwordx4 v[136:139], v16, s[24:27], s68 offen offset:0 sc1
    buffer_load_dwordx4 v[140:143], v16, s[24:27], s68 offen offset:1024 sc1
    s_add_u32 s68, s68, 57344
    v_exp_f32 v126, v126
    v_exp_f32 v127, v127
    v_cvt_pk_bf16_f32 v248, v120, v121
    v_cvt_pk_bf16_f32 v249, v122, v123
    v_cvt_pk_bf16_f32 v250, v124, v125
    v_cvt_pk_bf16_f32 v251, v126, v127
    v_mfma_f32_32x32x16_bf16 v[216:231], v[28:31], v[252:255], v[216:231]
    v_exp_f32 v128, v128
    v_exp_f32 v129, v129
    v_exp_f32 v130, v130
    v_mfma_f32_32x32x16_bf16 v[184:199], v[24:27], v[248:251], v[184:199]
    v_exp_f32 v131, v131
    v_exp_f32 v132, v132
    v_exp_f32 v133, v133
    v_exp_f32 v134, v134
    v_exp_f32 v135, v135
    v_cvt_pk_bf16_f32 v252, v128, v129
    v_cvt_pk_bf16_f32 v253, v130, v131
    v_cvt_pk_bf16_f32 v254, v132, v133
    v_cvt_pk_bf16_f32 v255, v134, v135
    v_mfma_f32_32x32x16_bf16 v[120:135], v[144:147], v[64:67], 0
    v_exp_f32 v104, v104
    v_exp_f32 v105, v105
    v_exp_f32 v106, v106
    v_mfma_f32_32x32x16_bf16 v[120:135], v[148:151], v[68:71], v[120:135]
    v_exp_f32 v107, v107
    v_exp_f32 v108, v108
    v_exp_f32 v109, v109
    v_exp_f32 v110, v110
    v_exp_f32 v111, v111
    v_cvt_pk_bf16_f32 v248, v104, v105
    v_cvt_pk_bf16_f32 v249, v106, v107
    v_cvt_pk_bf16_f32 v250, v108, v109
    v_cvt_pk_bf16_f32 v251, v110, v111
    v_mfma_f32_32x32x16_bf16 v[184:199], v[28:31], v[252:255], v[184:199]
    v_exp_f32 v112, v112
    v_exp_f32 v113, v113
    v_exp_f32 v114, v114
    s_waitcnt vmcnt(10)
    v_mfma_f32_32x32x16_bf16 v[152:167], v[32:35], v[248:251], v[152:167]
    v_exp_f32 v115, v115
    v_exp_f32 v116, v116
    v_exp_f32 v117, v117
    s_mov_b64 exec, s[66:67]
    buffer_load_dwordx4 v[24:27], v3, s[24:27], s69 offen sc1
    buffer_load_dwordx4 v[28:31], v23, s[24:27], s69 offen sc1
    s_mov_b64 exec, -1
    s_add_u32 s69, s69, 28672
    v_exp_f32 v118, v118
    v_exp_f32 v119, v119
    v_cvt_pk_bf16_f32 v252, v112, v113
    v_cvt_pk_bf16_f32 v253, v114, v115
    v_cvt_pk_bf16_f32 v254, v116, v117
    v_cvt_pk_bf16_f32 v255, v118, v119
    v_mfma_f32_32x32x16_bf16 v[104:119], v[144:147], v[72:75], 0
    v_exp_f32 v120, v120
    v_exp_f32 v121, v121
    v_exp_f32 v122, v122
    v_mfma_f32_32x32x16_bf16 v[104:119], v[148:151], v[76:79], v[104:119]
    v_exp_f32 v123, v123
    v_exp_f32 v124, v124
    v_exp_f32 v125, v125
    v_exp_f32 v126, v126
    v_exp_f32 v127, v127
    v_cvt_pk_bf16_f32 v248, v120, v121
    v_cvt_pk_bf16_f32 v249, v122, v123
    v_cvt_pk_bf16_f32 v250, v124, v125
    v_cvt_pk_bf16_f32 v251, v126, v127
    v_mfma_f32_32x32x16_bf16 v[152:167], v[36:39], v[252:255], v[152:167]
    v_exp_f32 v128, v128
    v_exp_f32 v129, v129
    v_exp_f32 v130, v130
    v_mfma_f32_32x32x16_bf16 v[168:183], v[32:35], v[248:251], v[168:183]
    v_exp_f32 v131, v131
    v_exp_f32 v132, v132
    v_exp_f32 v133, v133
    v_exp_f32 v134, v134
    v_exp_f32 v135, v135
    v_cvt_pk_bf16_f32 v252, v128, v129
    v_cvt_pk_bf16_f32 v253, v130, v131
    v_cvt_pk_bf16_f32 v254, v132, v133
    v_cvt_pk_bf16_f32 v255, v134, v135
    v_mfma_f32_32x32x16_bf16 v[120:135], v[144:147], v[80:83], 0
    v_exp_f32 v104, v104
    v_exp_f32 v105, v105
    v_exp_f32 v106, v106
    v_mfma_f32_32x32x16_bf16 v[120:135], v[148:151], v[84:87], v[120:135]
    v_exp_f32 v107, v107
    v_exp_f32 v108, v108
    v_exp_f32 v109, v109
    v_exp_f32 v110, v110
    v_exp_f32 v111, v111
    v_cvt_pk_bf16_f32 v248, v104, v105
    v_cvt_pk_bf16_f32 v249, v106, v107
    v_cvt_pk_bf16_f32 v250, v108, v109
    v_cvt_pk_bf16_f32 v251, v110, v111
    v_mfma_f32_32x32x16_bf16 v[168:183], v[36:39], v[252:255], v[168:183]
    v_exp_f32 v112, v112
    v_exp_f32 v113, v113
    v_exp_f32 v114, v114
    v_mfma_f32_32x32x16_bf16 v[216:231], v[32:35], v[248:251], v[216:231]
    v_exp_f32 v115, v115
    v_exp_f32 v116, v116
    v_exp_f32 v117, v117
    v_exp_f32 v118, v118
    v_exp_f32 v119, v119
    v_cvt_pk_bf16_f32 v252, v112, v113
    v_cvt_pk_bf16_f32 v253, v114, v115
    v_cvt_pk_bf16_f32 v254, v116, v117
    v_cvt_pk_bf16_f32 v255, v118, v119
    s_waitcnt vmcnt(10)
    v_mfma_f32_32x32x16_bf16 v[104:119], v[88:91], v[56:59], 0
    v_exp_f32 v120, v120
    v_exp_f32 v121, v121
    v_exp_f32 v122, v122
    v_mfma_f32_32x32x16_bf16 v[104:119], v[92:95], v[60:63], v[104:119]
    v_exp_f32 v123, v123
    v_exp_f32 v124, v124
    v_exp_f32 v125, v125
    buffer_load_dwordx4 v[144:147], v16, s[24:27], s68 offen offset:0 sc1
    buffer_load_dwordx4 v[148:151], v16, s[24:27], s68 offen offset:1024 sc1
    s_add_u32 s68, s68, 57344
    v_exp_f32 v126, v126
    v_exp_f32 v127, v127
    v_cvt_pk_bf16_f32 v248, v120, v121
    v_cvt_pk_bf16_f32 v249, v122, v123
    v_cvt_pk_bf16_f32 v250, v124, v125
    v_cvt_pk_bf16_f32 v251, v126, v127
    v_mfma_f32_32x32x16_bf16 v[216:231], v[36:39], v[252:255], v[216:231]
    v_exp_f32 v128, v128
    v_exp_f32 v129, v129
    v_exp_f32 v130, v130
    v_mfma_f32_32x32x16_bf16 v[184:199], v[32:35], v[248:251], v[184:199]
    v_exp_f32 v131, v131
    v_exp_f32 v132, v132
    v_exp_f32 v133, v133
    v_exp_f32 v134, v134
    v_exp_f32 v135, v135
    v_cvt_pk_bf16_f32 v252, v128, v129
    v_cvt_pk_bf16_f32 v253, v130, v131
    v_cvt_pk_bf16_f32 v254, v132, v133
    v_cvt_pk_bf16_f32 v255, v134, v135
    v_mfma_f32_32x32x16_bf16 v[120:135], v[88:91], v[64:67], 0
    v_exp_f32 v104, v104
    v_exp_f32 v105, v105
    v_exp_f32 v106, v106
    v_mfma_f32_32x32x16_bf16 v[120:135], v[92:95], v[68:71], v[120:135]
    v_exp_f32 v107, v107
    v_exp_f32 v108, v108
    v_exp_f32 v109, v109
    v_exp_f32 v110, v110
    v_exp_f32 v111, v111
    v_cvt_pk_bf16_f32 v248, v104, v105
    v_cvt_pk_bf16_f32 v249, v106, v107
    v_cvt_pk_bf16_f32 v250, v108, v109
    v_cvt_pk_bf16_f32 v251, v110, v111
    v_mfma_f32_32x32x16_bf16 v[184:199], v[36:39], v[252:255], v[184:199]
    v_exp_f32 v112, v112
    v_exp_f32 v113, v113
    v_exp_f32 v114, v114
    s_waitcnt vmcnt(10)
    v_mfma_f32_32x32x16_bf16 v[152:167], v[40:43], v[248:251], v[152:167]
    v_exp_f32 v115, v115
    v_exp_f32 v116, v116
    v_exp_f32 v117, v117
    s_mov_b64 exec, s[66:67]
    buffer_load_dwordx4 v[32:35], v3, s[24:27], s69 offen sc1
    buffer_load_dwordx4 v[36:39], v23, s[24:27], s69 offen sc1
    s_mov_b64 exec, -1
    s_add_u32 s69, s69, 28672
    v_exp_f32 v118, v118
    v_exp_f32 v119, v119
    v_cvt_pk_bf16_f32 v252, v112, v113
    v_cvt_pk_bf16_f32 v253, v114, v115
    v_cvt_pk_bf16_f32 v254, v116, v117
    v_cvt_pk_bf16_f32 v255, v118, v119
    v_mfma_f32_32x32x16_bf16 v[104:119], v[88:91], v[72:75], 0
    v_exp_f32 v120, v120
    v_exp_f32 v121, v121
    v_exp_f32 v122, v122
    v_mfma_f32_32x32x16_bf16 v[104:119], v[92:95], v[76:79], v[104:119]
    v_exp_f32 v123, v123
    v_exp_f32 v124, v124
    v_exp_f32 v125, v125
    v_cmp_ne_u64 vcc, s[60:61], v[18:19]
    s_nop 4
    s_cbranch_vccnz L_gf_28
    buffer_load_dword v17, v5, s[24:27], s47 offen sc1
    s_mov_b32 s64, 1
L_gf_28:
    buffer_load_dwordx2 v[18:19], v2, s[24:27], 0 offen sc1
    v_exp_f32 v126, v126
    v_exp_f32 v127, v127
    v_cvt_pk_bf16_f32 v248, v120, v121
    v_cvt_pk_bf16_f32 v249, v122, v123
    v_cvt_pk_bf16_f32 v250, v124, v125
    v_cvt_pk_bf16_f32 v251, v126, v127
    v_mfma_f32_32x32x16_bf16 v[152:167], v[44:47], v[252:255], v[152:167]
    v_exp_f32 v128, v128
    v_exp_f32 v129, v129
    v_exp_f32 v130, v130
    v_mfma_f32_32x32x16_bf16 v[168:183], v[40:43], v[248:251], v[168:183]
    v_exp_f32 v131, v131
    v_exp_f32 v132, v132
    v_exp_f32 v133, v133
    v_exp_f32 v134, v134
    v_exp_f32 v135, v135
    v_cvt_pk_bf16_f32 v252, v128, v129
    v_cvt_pk_bf16_f32 v253, v130, v131
    v_cvt_pk_bf16_f32 v254, v132, v133
    v_cvt_pk_bf16_f32 v255, v134, v135
    v_mfma_f32_32x32x16_bf16 v[120:135], v[88:91], v[80:83], 0
    v_exp_f32 v104, v104
    v_exp_f32 v105, v105
    v_exp_f32 v106, v106
    v_mfma_f32_32x32x16_bf16 v[120:135], v[92:95], v[84:87], v[120:135]
    v_exp_f32 v107, v107
    v_exp_f32 v108, v108
    v_exp_f32 v109, v109
    v_exp_f32 v110, v110
    v_exp_f32 v111, v111
    v_cvt_pk_bf16_f32 v248, v104, v105
    v_cvt_pk_bf16_f32 v249, v106, v107
    v_cvt_pk_bf16_f32 v250, v108, v109
    v_cvt_pk_bf16_f32 v251, v110, v111
    v_mfma_f32_32x32x16_bf16 v[168:183], v[44:47], v[252:255], v[168:183]
    v_exp_f32 v112, v112
    v_exp_f32 v113, v113
    v_exp_f32 v114, v114
    v_mfma_f32_32x32x16_bf16 v[216:231], v[40:43], v[248:251], v[216:231]
    v_exp_f32 v115, v115
    v_exp_f32 v116, v116
    v_exp_f32 v117, v117
    v_exp_f32 v118, v118
    v_exp_f32 v119, v119
    v_cvt_pk_bf16_f32 v252, v112, v113
    v_cvt_pk_bf16_f32 v253, v114, v115
    v_cvt_pk_bf16_f32 v254, v116, v117
    v_cvt_pk_bf16_f32 v255, v118, v119
    s_waitcnt vmcnt(10)
    v_mfma_f32_32x32x16_bf16 v[104:119], v[96:99], v[56:59], 0
    v_exp_f32 v120, v120
    v_exp_f32 v121, v121
    v_exp_f32 v122, v122
    v_mfma_f32_32x32x16_bf16 v[104:119], v[100:103], v[60:63], v[104:119]
    v_exp_f32 v123, v123
    v_exp_f32 v124, v124
    v_exp_f32 v125, v125
    ds_read_b32 v22, v10 offset:4
    buffer_load_dwordx4 v[88:91], v16, s[24:27], s68 offen offset:0 sc1
    buffer_load_dwordx4 v[92:95], v16, s[24:27], s68 offen offset:1024 sc1
    s_add_u32 s68, s68, 57344
    v_exp_f32 v126, v126
    v_exp_f32 v127, v127
    v_cvt_pk_bf16_f32 v248, v120, v121
    v_cvt_pk_bf16_f32 v249, v122, v123
    v_cvt_pk_bf16_f32 v250, v124, v125
    v_cvt_pk_bf16_f32 v251, v126, v127
    v_mfma_f32_32x32x16_bf16 v[216:231], v[44:47], v[252:255], v[216:231]
    v_exp_f32 v128, v128
    v_exp_f32 v129, v129
    v_exp_f32 v130, v130
    v_mfma_f32_32x32x16_bf16 v[184:199], v[40:43], v[248:251], v[184:199]
    v_exp_f32 v131, v131
    v_exp_f32 v132, v132
    v_exp_f32 v133, v133
    v_exp_f32 v134, v134
    v_exp_f32 v135, v135
    v_cvt_pk_bf16_f32 v252, v128, v129
    v_cvt_pk_bf16_f32 v253, v130, v131
    v_cvt_pk_bf16_f32 v254, v132, v133
    v_cvt_pk_bf16_f32 v255, v134, v135
    v_mfma_f32_32x32x16_bf16 v[120:135], v[96:99], v[64:67], 0
    v_exp_f32 v104, v104
    v_exp_f32 v105, v105
    v_exp_f32 v106, v106
    v_mfma_f32_32x32x16_bf16 v[120:135], v[100:103], v[68:71], v[120:135]
    v_exp_f32 v107, v107
    v_exp_f32 v108, v108
    v_exp_f32 v109, v109
    v_exp_f32 v110, v110
    v_exp_f32 v111, v111
    v_cvt_pk_bf16_f32 v248, v104, v105
    v_cvt_pk_bf16_f32 v249, v106, v107
    v_cvt_pk_bf16_f32 v250, v108, v109
    v_cvt_pk_bf16_f32 v251, v110, v111
    v_mfma_f32_32x32x16_bf16 v[184:199], v[44:47], v[252:255], v[184:199]
    v_exp_f32 v112, v112
    v_exp_f32 v113, v113
    v_exp_f32 v114, v114
    s_waitcnt vmcnt(10)
    v_mfma_f32_32x32x16_bf16 v[152:167], v[48:51], v[248:251], v[152:167]
    v_exp_f32 v115, v115
    v_exp_f32 v116, v116
    v_exp_f32 v117, v117
    s_mov_b64 exec, s[66:67]
    buffer_load_dwordx4 v[40:43], v3, s[24:27], s69 offen sc1
    buffer_load_dwordx4 v[44:47], v23, s[24:27], s69 offen sc1
    s_mov_b64 exec, -1
    s_add_u32 s69, s69, 28672
    v_exp_f32 v118, v118
    v_exp_f32 v119, v119
    v_cvt_pk_bf16_f32 v252, v112, v113
    v_cvt_pk_bf16_f32 v253, v114, v115
    v_cvt_pk_bf16_f32 v254, v116, v117
    v_cvt_pk_bf16_f32 v255, v118, v119
    v_mfma_f32_32x32x16_bf16 v[104:119], v[96:99], v[72:75], 0
    v_exp_f32 v120, v120
    v_exp_f32 v121, v121
    v_exp_f32 v122, v122
    v_mfma_f32_32x32x16_bf16 v[104:119], v[100:103], v[76:79], v[104:119]
    v_exp_f32 v123, v123
    v_exp_f32 v124, v124
    v_exp_f32 v125, v125
    v_exp_f32 v126, v126
    v_exp_f32 v127, v127
    v_cvt_pk_bf16_f32 v248, v120, v121
    v_cvt_pk_bf16_f32 v249, v122, v123
    v_cvt_pk_bf16_f32 v250, v124, v125
    v_cvt_pk_bf16_f32 v251, v126, v127
    v_mfma_f32_32x32x16_bf16 v[152:167], v[52:55], v[252:255], v[152:167]
    v_exp_f32 v128, v128
    v_exp_f32 v129, v129
    v_exp_f32 v130, v130
    v_mfma_f32_32x32x16_bf16 v[168:183], v[48:51], v[248:251], v[168:183]
    v_exp_f32 v131, v131
    v_exp_f32 v132, v132
    v_exp_f32 v133, v133
    v_exp_f32 v134, v134
    v_exp_f32 v135, v135
    v_cvt_pk_bf16_f32 v252, v128, v129
    v_cvt_pk_bf16_f32 v253, v130, v131
    v_cvt_pk_bf16_f32 v254, v132, v133
    v_cvt_pk_bf16_f32 v255, v134, v135
    v_mfma_f32_32x32x16_bf16 v[120:135], v[96:99], v[80:83], 0
    v_exp_f32 v104, v104
    v_exp_f32 v105, v105
    v_exp_f32 v106, v106
    v_mfma_f32_32x32x16_bf16 v[120:135], v[100:103], v[84:87], v[120:135]
    v_exp_f32 v107, v107
    v_exp_f32 v108, v108
    v_exp_f32 v109, v109
    v_exp_f32 v110, v110
    v_exp_f32 v111, v111
    v_cvt_pk_bf16_f32 v248, v104, v105
    v_cvt_pk_bf16_f32 v249, v106, v107
    v_cvt_pk_bf16_f32 v250, v108, v109
    v_cvt_pk_bf16_f32 v251, v110, v111
    v_mfma_f32_32x32x16_bf16 v[168:183], v[52:55], v[252:255], v[168:183]
    v_exp_f32 v112, v112
    v_exp_f32 v113, v113
    v_exp_f32 v114, v114
    v_mfma_f32_32x32x16_bf16 v[216:231], v[48:51], v[248:251], v[216:231]
    v_exp_f32 v115, v115
    v_exp_f32 v116, v116
    v_exp_f32 v117, v117
    v_exp_f32 v118, v118
    v_exp_f32 v119, v119
    v_cvt_pk_bf16_f32 v252, v112, v113
    v_cvt_pk_bf16_f32 v253, v114, v115
    v_cvt_pk_bf16_f32 v254, v116, v117
    v_cvt_pk_bf16_f32 v255, v118, v119
    s_waitcnt vmcnt(10)
    v_mfma_f32_32x32x16_bf16 v[104:119], v[136:139], v[56:59], 0
    v_exp_f32 v120, v120
    v_exp_f32 v121, v121
    v_exp_f32 v122, v122
    v_mfma_f32_32x32x16_bf16 v[104:119], v[140:143], v[60:63], v[104:119]
    v_exp_f32 v123, v123
    v_exp_f32 v124, v124
    v_exp_f32 v125, v125
    buffer_load_dwordx4 v[96:99], v16, s[24:27], s68 offen offset:0 sc1
    buffer_load_dwordx4 v[100:103], v16, s[24:27], s68 offen offset:1024 sc1
    s_add_u32 s68, s68, 57344
    v_exp_f32 v126, v126
    v_exp_f32 v127, v127
    v_cvt_pk_bf16_f32 v248, v120, v121
    v_cvt_pk_bf16_f32 v249, v122, v123
    v_cvt_pk_bf16_f32 v250, v124, v125
    v_cvt_pk_bf16_f32 v251, v126, v127
    v_mfma_f32_32x32x16_bf16 v[216:231], v[52:55], v[252:255], v[216:231]
    v_exp_f32 v128, v128
    v_exp_f32 v129, v129
    v_exp_f32 v130, v130
    v_mfma_f32_32x32x16_bf16 v[184:199], v[48:51], v[248:251], v[184:199]
    v_exp_f32 v131, v131
    v_exp_f32 v132, v132
    v_exp_f32 v133, v133
    v_exp_f32 v134, v134
    v_exp_f32 v135, v135
    v_cvt_pk_bf16_f32 v252, v128, v129
    v_cvt_pk_bf16_f32 v253, v130, v131
    v_cvt_pk_bf16_f32 v254, v132, v133
    v_cvt_pk_bf16_f32 v255, v134, v135
    s_add_u32 s70, s70, 1
    s_cmp_lt_u32 s70, 4
    s_cbranch_scc1 L_attn_loop
    v_mfma_f32_32x32x16_bf16 v[184:199], v[52:55], v[252:255], v[184:199]
    s_waitcnt lgkmcnt(0)
    v_readfirstlane_b32 s50, v22
    s_nop 0
    s_cmp_ge_u32 s50, 8
    s_cbranch_scc1 L_ringok_29
    v_mov_b32 v22, 155652
    s_mov_b32 s58, 0x100000
L_cnt_30:
    ds_read_b32 v21, v22
    s_waitcnt lgkmcnt(0)
    v_readfirstlane_b32 s50, v21
    s_nop 0
    s_cmp_ge_u32 s50, 8
    s_cbranch_scc1 L_cntd_31
    s_sub_u32 s58, s58, 1
    s_cmp_lg_u32 s58, 0
    s_cbranch_scc1 L_cnt_30
L_cntd_31:
L_ringok_29:
    s_cmp_eq_u32 s64, 1
    s_cbranch_scc1 L_gok_32
    s_mov_b32 s58, 0x4000
L_poll_33:
    buffer_load_dwordx2 v[18:19], v2, s[24:27], 0 offen sc1
    s_waitcnt vmcnt(0)
    v_cmp_ne_u64 vcc, s[60:61], v[18:19]
    s_nop 4
    s_cbranch_vccz L_polld_34
    s_sleep 2
    s_sub_u32 s58, s58, 1
    s_cmp_lg_u32 s58, 0
    s_cbranch_scc1 L_poll_33
L_polld_34:
    buffer_load_dword v17, v5, s[24:27], s47 offen sc1
L_gok_32:
    ds_write_b128 v6, v[152:155] offset:0
    ds_write_b128 v6, v[156:159] offset:1024
    ds_write_b128 v6, v[160:163] offset:2048
    ds_write_b128 v6, v[164:167] offset:3072
    ds_write_b128 v7, v[168:171] offset:0
    ds_write_b128 v7, v[172:175] offset:1024
    ds_write_b128 v7, v[176:179] offset:2048
    ds_write_b128 v7, v[180:183] offset:3072
    ds_write_b128 v8, v[216:219] offset:0
    ds_write_b128 v8, v[220:223] offset:1024
    ds_write_b128 v8, v[224:227] offset:2048
    ds_write_b128 v8, v[228:231] offset:3072
    s_waitcnt lgkmcnt(0)
    s_mov_b64 exec, 1
    ds_add_u32 v10, v11
    s_mov_b64 exec, -1
    s_mov_b32 s58, 0x100000
L_cnt_35:
    ds_read_b32 v11, v10
    s_waitcnt lgkmcnt(0)
    v_readfirstlane_b32 s50, v11
    s_nop 0
    s_cmp_ge_u32 s50, 4
    s_cbranch_scc1 L_cntd_36
    s_sub_u32 s58, s58, 1
    s_cmp_lg_u32 s58, 0
    s_cbranch_scc1 L_cnt_35
L_cntd_36:
    ds_read_b128 v[152:155], v15 offset:0
    ds_read_b128 v[156:159], v15 offset:1024
    ds_read_b128 v[160:163], v15 offset:2048
    ds_read_b128 v[164:167], v15 offset:3072
    ds_read_b128 v[168:171], v15 offset:4096
    ds_read_b128 v[172:175], v15 offset:5120
    ds_read_b128 v[176:179], v15 offset:6144
    ds_read_b128 v[180:183], v15 offset:7168
    ds_read_b128 v[216:219], v15 offset:8192
    ds_read_b128 v[220:223], v15 offset:9216
    ds_read_b128 v[224:227], v15 offset:10240
    ds_read_b128 v[228:231], v15 offset:11264
    s_mov_b32 s50, 0x1f800000
    s_mov_b32 s51, 0x5f800000
    s_waitcnt lgkmcnt(8)
    v_add_f32 v184, v184, v152
    v_add_f32 v185, v185, v153
    v_add_f32 v186, v186, v154
    v_add_f32 v187, v187, v155
    v_add_f32 v188, v188, v156
    v_add_f32 v189, v189, v157
    v_add_f32 v190, v190, v158
    v_add_f32 v191, v191, v159
    v_add_f32 v192, v192, v160
    v_add_f32 v193, v193, v161
    v_add_f32 v194, v194, v162
    v_add_f32 v195, v195, v163
    v_add_f32 v196, v196, v164
    v_add_f32 v197, v197, v165
    v_add_f32 v198, v198, v166
    v_add_f32 v199, v199, v167
    s_waitcnt lgkmcnt(4)
    v_add_f32 v184, v184, v168
    v_add_f32 v185, v185, v169
    v_add_f32 v186, v186, v170
    v_add_f32 v187, v187, v171
    v_add_f32 v188, v188, v172
    v_add_f32 v189, v189, v173
    v_add_f32 v190, v190, v174
    v_add_f32 v191, v191, v175
    v_add_f32 v192, v192, v176
    v_add_f32 v193, v193, v177
    v_add_f32 v194, v194, v178
    v_add_f32 v195, v195, v179
    v_add_f32 v196, v196, v180
    v_add_f32 v197, v197, v181
    v_add_f32 v198, v198, v182
    v_add_f32 v199, v199, v183
    s_waitcnt lgkmcnt(0)
    v_add_f32 v184, v184, v216
    v_add_f32 v185, v185, v217
    v_add_f32 v186, v186, v218
    v_add_f32 v187, v187, v219
    v_add_f32 v188, v188, v220
    v_add_f32 v189, v189, v221
    v_add_f32 v190, v190, v222
    v_add_f32 v191, v191, v223
    v_add_f32 v192, v192, v224
    v_add_f32 v193, v193, v225
    v_add_f32 v194, v194, v226
    v_add_f32 v195, v195, v227
    v_add_f32 v196, v196, v228
    v_add_f32 v197, v197, v229
    v_add_f32 v198, v198, v230
    v_add_f32 v199, v199, v231
    v_mov_b32 v2, v196
    v_mov_b32 v9, v196
    s_nop 1
    v_permlane32_swap_b32 v2, v9
    v_cmp_le_f32 vcc, s50, v9
    v_cmp_ge_f32 s[52:53], s51, v9
    s_nop 0
    s_and_b64 s[52:53], s[52:53], vcc
    v_max_i32 v152, v184, v185
    v_max_u32 v153, v184, v185
    v_max3_i32 v152, v186, v187, v152
    v_max3_u32 v153, v186, v187, v153
    v_max3_i32 v152, v188, v189, v152
    v_max3_u32 v153, v188, v189, v153
    v_max3_i32 v152, v190, v191, v152
    v_max3_u32 v153, v190, v191, v153
    v_max3_i32 v152, v192, v193, v152
    v_max3_u32 v153, v192, v193, v153
    v_max3_i32 v152, v194, v195, v152
    v_max3_u32 v153, v194, v195, v153
    v_max3_i32 v152, v196, v197, v152
    v_max3_u32 v153, v196, v197, v153
    v_max3_i32 v152, v198, v199, v152
    v_max3_u32 v153, v198, v199, v153
    v_cmp_gt_i32 vcc, 0x7f800000, v152
    s_nop 0
    s_and_b64 s[52:53], s[52:53], vcc
    v_cmp_gt_u32 vcc, 0xff800000, v153
    s_nop 0
    s_and_b64 s[52:53], s[52:53], vcc
    s_cmp_eq_u64 s[52:53], -1
    s_cbranch_scc0 L_slow
L_ofin:
    s_waitcnt vmcnt(0)
    v_rcp_f32 v9, v9
    s_nop 0
    v_mul_f32 v9, v9, v17
    v_mul_f32 v184, v184, v9
    v_mul_f32 v185, v185, v9
    v_mul_f32 v186, v186, v9
    v_mul_f32 v187, v187, v9
    v_mul_f32 v188, v188, v9
    v_mul_f32 v189, v189, v9
    v_mul_f32 v190, v190, v9
    v_mul_f32 v191, v191, v9
    v_cvt_pk_bf16_f32 v248, v184, v185
    v_cvt_pk_bf16_f32 v249, v186, v187
    v_cvt_pk_bf16_f32 v250, v188, v189
    v_cvt_pk_bf16_f32 v251, v190, v191
    v_min_u32 v248, -2, v248
    v_min_u32 v249, -2, v249
    v_min_u32 v250, -2, v250
    v_min_u32 v251, -2, v251
    buffer_store_dwordx4 v[248:251], v16, s[24:27], s46 offen offset:0 sc1
    v_mul_f32 v192, v192, v9
    v_mul_f32 v193, v193, v9
    v_mul_f32 v194, v194, v9
    v_mul_f32 v195, v195, v9
    v_mul_f32 v196, v196, v9
    v_mul_f32 v197, v197, v9
    v_mul_f32 v198, v198, v9
    v_mul_f32 v199, v199, v9
    v_cvt_pk_bf16_f32 v252, v192, v193
    v_cvt_pk_bf16_f32 v253, v194, v195
    v_cvt_pk_bf16_f32 v254, v196, v197
    v_cvt_pk_bf16_f32 v255, v198, v199
    s_mov_b32 exec_lo, 0
    v_mov_b32 v254, 0
    v_mov_b32 v255, 0
    s_mov_b64 exec, -1
    v_min_u32 v252, -2, v252
    v_min_u32 v253, -2, v253
    v_min_u32 v254, -2, v254
    v_min_u32 v255, -2, v255
    buffer_store_dwordx4 v[252:255], v16, s[24:27], s46 offen offset:1024 sc1
    v_mov_b32 v11, 1
    s_waitcnt vmcnt(0)
    s_mov_b64 exec, 1
    ds_add_u32 v10, v11 offset:12
    s_mov_b64 exec, -1
    s_endpgm
L_G:
    s_lshl_b32 s66, s44, 11
    s_mul_i32 s67, s44, 401408
    s_mul_i32 s62, s44, 100352
    v_lshrrev_b32 v18, 3, v1
    v_mul_u32_u24 v18, 896, v18
    v_bfe_u32 v19, v1, 1, 2
    v_bfe_u32 v15, v1, 4, 1
    v_lshlrev_b32 v15, 1, v15
    v_xor_b32 v19, v19, v15
    v_lshl_add_u32 v18, v19, 5, v18
    v_and_b32 v19, 1, v1
    v_lshl_add_u32 v18, v19, 4, v18
    s_lshl_b32 s51, s65, 7
    v_add_u32 v15, s51, v18
    s_setprio 3
    v_xor_b32 v252, 131072, v9
    v_xor_b32 v253, 131104, v9
    s_waitcnt lgkmcnt(6)
    v_mfma_f32_32x32x16_bf16 v[152:167], v[224:227], v[128:131], v[152:167]
    ds_read_b64_tr_b16 v[216:217], v252 offset:0
    ds_read_b64_tr_b16 v[218:219], v252 offset:512
    s_waitcnt lgkmcnt(6)
    v_mfma_f32_32x32x16_bf16 v[168:183], v[228:231], v[128:131], v[168:183]
    ds_read_b64_tr_b16 v[220:221], v253 offset:0
    ds_read_b64_tr_b16 v[222:223], v253 offset:512
    s_waitcnt lgkmcnt(6)
    v_mfma_f32_32x32x16_bf16 v[152:167], v[232:235], v[132:135], v[152:167]
    ds_read_b64_tr_b16 v[224:225], v252 offset:2048
    ds_read_b64_tr_b16 v[226:227], v252 offset:2560
    s_waitcnt lgkmcnt(6)
    v_mfma_f32_32x32x16_bf16 v[168:183], v[236:239], v[132:135], v[168:183]
    ds_read_b64_tr_b16 v[228:229], v253 offset:2048
    ds_read_b64_tr_b16 v[230:231], v253 offset:2560
    s_waitcnt lgkmcnt(6)
    v_mfma_f32_32x32x16_bf16 v[184:199], v[216:219], v[24:27], 0
    ds_read_b64_tr_b16 v[232:233], v252 offset:4096
    ds_read_b64_tr_b16 v[234:235], v252 offset:4608
    s_nop 1
    v_mul_f32 v240, v152, v152
    v_mul_f32 v241, v153, v153
    v_mul_f32 v242, v154, v154
    v_mul_f32 v243, v155, v155
    s_waitcnt lgkmcnt(6)
    v_mfma_f32_32x32x16_bf16 v[200:215], v[220:223], v[24:27], 0
    ds_read_b64_tr_b16 v[236:237], v253 offset:4096
    ds_read_b64_tr_b16 v[238:239], v253 offset:4608
    v_mul_f32 v244, v156, v156
    v_mul_f32 v245, v157, v157
    v_mul_f32 v246, v158, v158
    v_mul_f32 v247, v159, v159
    s_waitcnt lgkmcnt(6)
    v_mfma_f32_32x32x16_bf16 v[184:199], v[224:227], v[28:31], v[184:199]
    ds_read_b64_tr_b16 v[216:217], v252 offset:6144
    ds_read_b64_tr_b16 v[218:219], v252 offset:6656
    v_fmamk_f32 v240, v240, 0xbdd2d3e8, v11
    v_fmamk_f32 v241, v241, 0xbdd2d3e8, v11
    v_fmamk_f32 v242, v242, 0xbdd2d3e8, v11
    v_fmamk_f32 v243, v243, 0xbdd2d3e8, v11
    s_waitcnt lgkmcnt(6)
    v_mfma_f32_32x32x16_bf16 v[200:215], v[228:231], v[28:31], v[200:215]
    ds_read_b64_tr_b16 v[220:221], v253 offset:6144
    ds_read_b64_tr_b16 v[222:223], v253 offset:6656
    v_fmamk_f32 v244, v244, 0xbdd2d3e8, v11
    v_fmamk_f32 v245, v245, 0xbdd2d3e8, v11
    v_fmamk_f32 v246, v246, 0xbdd2d3e8, v11
    v_fmamk_f32 v247, v247, 0xbdd2d3e8, v11
    v_xor_b32 v252, 16384, v9
    v_xor_b32 v253, 16416, v9
    s_waitcnt lgkmcnt(6)
    v_mfma_f32_32x32x16_bf16 v[184:199], v[232:235], v[32:35], v[184:199]
    ds_read_b64_tr_b16 v[224:225], v252 offset:0
    ds_read_b64_tr_b16 v[226:227], v252 offset:512
    v_mul_f32 v240, v240, v152
    v_mul_f32 v241, v241, v153
    v_mul_f32 v242, v242, v154
    v_mul_f32 v243, v243, v155
    s_waitcnt lgkmcnt(6)
    v_mfma_f32_32x32x16_bf16 v[200:215], v[236:239], v[32:35], v[200:215]
    ds_read_b64_tr_b16 v[228:229], v253 offset:0
    ds_read_b64_tr_b16 v[230:231], v253 offset:512
    v_mul_f32 v244, v244, v156
    v_mul_f32 v245, v245, v157
    v_mul_f32 v246, v246, v158
    v_mul_f32 v247, v247, v159
    s_waitcnt lgkmcnt(6)
    v_mfma_f32_32x32x16_bf16 v[184:199], v[216:219], v[36:39], v[184:199]
    ds_read_b64_tr_b16 v[232:233], v252 offset:2048
    ds_read_b64_tr_b16 v[234:235], v252 offset:2560
    v_exp_f32 v240, v240
    v_mul_f32 v152, v152, v160
    v_exp_f32 v241, v241
    v_mul_f32 v153, v153, v161
    s_waitcnt lgkmcnt(6)
    v_mfma_f32_32x32x16_bf16 v[200:215], v[220:223], v[36:39], v[200:215]
    ds_read_b64_tr_b16 v[236:237], v253 offset:2048
    ds_read_b64_tr_b16 v[238:239], v253 offset:2560
    v_exp_f32 v242, v242
    v_mul_f32 v154, v154, v162
    v_exp_f32 v243, v243
    v_mul_f32 v155, v155, v163
    s_waitcnt lgkmcnt(6)
    v_mfma_f32_32x32x16_bf16 v[184:199], v[224:227], v[40:43], v[184:199]
    ds_read_b64_tr_b16 v[216:217], v252 offset:4096
    ds_read_b64_tr_b16 v[218:219], v252 offset:4608
    v_exp_f32 v244, v244
    v_mul_f32 v156, v156, v164
    v_exp_f32 v245, v245
    v_mul_f32 v157, v157, v165
    s_waitcnt lgkmcnt(6)
    v_mfma_f32_32x32x16_bf16 v[200:215], v[228:231], v[40:43], v[200:215]
    ds_read_b64_tr_b16 v[220:221], v253 offset:4096
    ds_read_b64_tr_b16 v[222:223], v253 offset:4608
    v_exp_f32 v246, v246
    v_mul_f32 v158, v158, v166
    v_exp_f32 v247, v247
    v_mul_f32 v159, v159, v167
    s_waitcnt lgkmcnt(6)
    v_mfma_f32_32x32x16_bf16 v[184:199], v[232:235], v[44:47], v[184:199]
    ds_read_b64_tr_b16 v[224:225], v252 offset:6144
    ds_read_b64_tr_b16 v[226:227], v252 offset:6656
    v_add_f32 v240, 1.0, v240
    v_add_f32 v241, 1.0, v241
    v_add_f32 v242, 1.0, v242
    v_add_f32 v243, 1.0, v243
    s_waitcnt lgkmcnt(6)
    v_mfma_f32_32x32x16_bf16 v[200:215], v[236:239], v[44:47], v[200:215]
    ds_read_b64_tr_b16 v[228:229], v253 offset:6144
    ds_read_b64_tr_b16 v[230:231], v253 offset:6656
    v_add_f32 v244, 1.0, v244
    v_add_f32 v245, 1.0, v245
    v_add_f32 v246, 1.0, v246
    v_add_f32 v247, 1.0, v247
    s_waitcnt vmcnt(0)
    s_barrier
    v_xor_b32 v252, 32768, v9
    v_xor_b32 v253, 32800, v9
    s_waitcnt lgkmcnt(6)
    v_mfma_f32_32x32x16_bf16 v[184:199], v[216:219], v[48:51], v[184:199]
    ds_read_b64_tr_b16 v[232:233], v252 offset:0
    ds_read_b64_tr_b16 v[234:235], v252 offset:512
    v_rcp_f32 v240, v240
    v_rcp_f32 v241, v241
    v_rcp_f32 v242, v242
    v_rcp_f32 v243, v243
    s_waitcnt lgkmcnt(6)
    v_mfma_f32_32x32x16_bf16 v[200:215], v[220:223], v[48:51], v[200:215]
    ds_read_b64_tr_b16 v[236:237], v253 offset:0
    ds_read_b64_tr_b16 v[238:239], v253 offset:512
    v_rcp_f32 v244, v244
    v_rcp_f32 v245, v245
    v_rcp_f32 v246, v246
    v_rcp_f32 v247, v247
    s_waitcnt lgkmcnt(6)
    v_mfma_f32_32x32x16_bf16 v[184:199], v[224:227], v[52:55], v[184:199]
    ds_read_b64_tr_b16 v[216:217], v252 offset:2048
    ds_read_b64_tr_b16 v[218:219], v252 offset:2560
    v_mul_f32 v152, v152, v240
    v_mul_f32 v153, v153, v241
    v_mul_f32 v154, v154, v242
    v_mul_f32 v155, v155, v243
    s_waitcnt lgkmcnt(6)
    v_mfma_f32_32x32x16_bf16 v[200:215], v[228:231], v[52:55], v[200:215]
    ds_read_b64_tr_b16 v[220:221], v253 offset:2048
    ds_read_b64_tr_b16 v[222:223], v253 offset:2560
    v_mul_f32 v156, v156, v244
    v_mul_f32 v157, v157, v245
    v_mul_f32 v158, v158, v246
    v_mul_f32 v159, v159, v247
    s_waitcnt lgkmcnt(6)
    v_mfma_f32_32x32x16_bf16 v[184:199], v[232:235], v[56:59], v[184:199]
    ds_read_b64_tr_b16 v[224:225], v252 offset:4096
    ds_read_b64_tr_b16 v[226:227], v252 offset:4608
    v_cvt_pk_bf16_f32 v160, v152, v153
    v_cvt_pk_bf16_f32 v161, v154, v155
    v_cvt_pk_bf16_f32 v162, v156, v157
    v_cvt_pk_bf16_f32 v163, v158, v159
    s_waitcnt lgkmcnt(6)
    v_mfma_f32_32x32x16_bf16 v[200:215], v[236:239], v[56:59], v[200:215]
    ds_read_b64_tr_b16 v[228:229], v253 offset:4096
    ds_read_b64_tr_b16 v[230:231], v253 offset:4608
    s_add_u32 s57, s49, 0
    buffer_store_dwordx4 v[160:163], v16, s[24:27], s57 offen sc1
    v_mul_f32 v240, v168, v168
    v_mul_f32 v241, v169, v169
    v_mul_f32 v242, v170, v170
    s_waitcnt lgkmcnt(6)
    v_mfma_f32_32x32x16_bf16 v[184:199], v[216:219], v[60:63], v[184:199]
    ds_read_b64_tr_b16 v[232:233], v252 offset:6144
    ds_read_b64_tr_b16 v[234:235], v252 offset:6656
    v_mul_f32 v243, v171, v171
    v_mul_f32 v244, v172, v172
    v_mul_f32 v245, v173, v173
    v_mul_f32 v246, v174, v174
    s_waitcnt lgkmcnt(6)
    v_mfma_f32_32x32x16_bf16 v[200:215], v[220:223], v[60:63], v[200:215]
    ds_read_b64_tr_b16 v[236:237], v253 offset:6144
    ds_read_b64_tr_b16 v[238:239], v253 offset:6656
    v_mul_f32 v247, v175, v175
    v_fmamk_f32 v240, v240, 0xbdd2d3e8, v11
    v_fmamk_f32 v241, v241, 0xbdd2d3e8, v11
    v_fmamk_f32 v242, v242, 0xbdd2d3e8, v11
    v_xor_b32 v252, 49152, v9
    v_xor_b32 v253, 49184, v9
    s_waitcnt lgkmcnt(6)
    v_mfma_f32_32x32x16_bf16 v[184:199], v[224:227], v[64:67], v[184:199]
    ds_read_b64_tr_b16 v[216:217], v252 offset:0
    ds_read_b64_tr_b16 v[218:219], v252 offset:512
    v_fmamk_f32 v243, v243, 0xbdd2d3e8, v11
    v_fmamk_f32 v244, v244, 0xbdd2d3e8, v11
    v_fmamk_f32 v245, v245, 0xbdd2d3e8, v11
    v_fmamk_f32 v246, v246, 0xbdd2d3e8, v11
    s_waitcnt lgkmcnt(6)
    v_mfma_f32_32x32x16_bf16 v[200:215], v[228:231], v[64:67], v[200:215]
    ds_read_b64_tr_b16 v[220:221], v253 offset:0
    ds_read_b64_tr_b16 v[222:223], v253 offset:512
    v_fmamk_f32 v247, v247, 0xbdd2d3e8, v11
    v_mul_f32 v240, v240, v168
    v_mul_f32 v241, v241, v169
    v_mul_f32 v242, v242, v170
    s_waitcnt lgkmcnt(6)
    v_mfma_f32_32x32x16_bf16 v[184:199], v[232:235], v[68:71], v[184:199]
    ds_read_b64_tr_b16 v[224:225], v252 offset:2048
    ds_read_b64_tr_b16 v[226:227], v252 offset:2560
    v_mul_f32 v243, v243, v171
    v_mul_f32 v244, v244, v172
    v_mul_f32 v245, v245, v173
    v_mul_f32 v246, v246, v174
    s_waitcnt lgkmcnt(6)
    v_mfma_f32_32x32x16_bf16 v[200:215], v[236:239], v[68:71], v[200:215]
    ds_read_b64_tr_b16 v[228:229], v253 offset:2048
    ds_read_b64_tr_b16 v[230:231], v253 offset:2560
    v_mul_f32 v247, v247, v175
    v_exp_f32 v240, v240
    v_mul_f32 v168, v168, v176
    v_exp_f32 v241, v241
    s_waitcnt lgkmcnt(6)
    v_mfma_f32_32x32x16_bf16 v[184:199], v[216:219], v[72:75], v[184:199]
    ds_read_b64_tr_b16 v[232:233], v252 offset:4096
    ds_read_b64_tr_b16 v[234:235], v252 offset:4608
    v_mul_f32 v169, v169, v177
    v_exp_f32 v242, v242
    v_mul_f32 v170, v170, v178
    v_exp_f32 v243, v243
    s_waitcnt lgkmcnt(6)
    v_mfma_f32_32x32x16_bf16 v[200:215], v[220:223], v[72:75], v[200:215]
    ds_read_b64_tr_b16 v[236:237], v253 offset:4096
    ds_read_b64_tr_b16 v[238:239], v253 offset:4608
    v_mul_f32 v171, v171, v179
    v_exp_f32 v244, v244
    v_mul_f32 v172, v172, v180
    v_exp_f32 v245, v245
    s_waitcnt lgkmcnt(6)
    v_mfma_f32_32x32x16_bf16 v[184:199], v[224:227], v[76:79], v[184:199]
    ds_read_b64_tr_b16 v[216:217], v252 offset:6144
    ds_read_b64_tr_b16 v[218:219], v252 offset:6656
    v_mul_f32 v173, v173, v181
    v_exp_f32 v246, v246
    v_mul_f32 v174, v174, v182
    v_exp_f32 v247, v247
    s_waitcnt lgkmcnt(6)
    v_mfma_f32_32x32x16_bf16 v[200:215], v[228:231], v[76:79], v[200:215]
    ds_read_b64_tr_b16 v[220:221], v253 offset:6144
    ds_read_b64_tr_b16 v[222:223], v253 offset:6656
    v_mul_f32 v175, v175, v183
    v_add_f32 v240, 1.0, v240
    v_add_f32 v241, 1.0, v241
    v_add_f32 v242, 1.0, v242
    v_xor_b32 v252, 65536, v9
    v_xor_b32 v253, 65568, v9
    s_waitcnt lgkmcnt(6)
    v_mfma_f32_32x32x16_bf16 v[184:199], v[232:235], v[80:83], v[184:199]
    ds_read_b64_tr_b16 v[224:225], v252 offset:0
    ds_read_b64_tr_b16 v[226:227], v252 offset:512
    v_add_f32 v243, 1.0, v243
    v_add_f32 v244, 1.0, v244
    v_add_f32 v245, 1.0, v245
    v_add_f32 v246, 1.0, v246
    s_waitcnt lgkmcnt(6)
    v_mfma_f32_32x32x16_bf16 v[200:215], v[236:239], v[80:83], v[200:215]
    ds_read_b64_tr_b16 v[228:229], v253 offset:0
    ds_read_b64_tr_b16 v[230:231], v253 offset:512
    v_add_f32 v247, 1.0, v247
    v_rcp_f32 v240, v240
    v_rcp_f32 v241, v241
    v_rcp_f32 v242, v242
    s_waitcnt lgkmcnt(6)
    v_mfma_f32_32x32x16_bf16 v[184:199], v[216:219], v[84:87], v[184:199]
    ds_read_b64_tr_b16 v[232:233], v252 offset:2048
    ds_read_b64_tr_b16 v[234:235], v252 offset:2560
    v_rcp_f32 v243, v243
    v_rcp_f32 v244, v244
    v_rcp_f32 v245, v245
    v_rcp_f32 v246, v246
    s_waitcnt lgkmcnt(6)
    v_mfma_f32_32x32x16_bf16 v[200:215], v[220:223], v[84:87], v[200:215]
    ds_read_b64_tr_b16 v[236:237], v253 offset:2048
    ds_read_b64_tr_b16 v[238:239], v253 offset:2560
    v_rcp_f32 v247, v247
    v_mul_f32 v168, v168, v240
    v_mul_f32 v169, v169, v241
    v_mul_f32 v170, v170, v242
    s_waitcnt lgkmcnt(6)
    v_mfma_f32_32x32x16_bf16 v[184:199], v[224:227], v[88:91], v[184:199]
    ds_read_b64_tr_b16 v[216:217], v252 offset:4096
    ds_read_b64_tr_b16 v[218:219], v252 offset:4608
    v_mul_f32 v171, v171, v243
    v_mul_f32 v172, v172, v244
    v_mul_f32 v173, v173, v245
    v_mul_f32 v174, v174, v246
    s_waitcnt lgkmcnt(6)
    v_mfma_f32_32x32x16_bf16 v[200:215], v[228:231], v[88:91], v[200:215]
    ds_read_b64_tr_b16 v[220:221], v253 offset:4096
    ds_read_b64_tr_b16 v[222:223], v253 offset:4608
    v_mul_f32 v175, v175, v247
    v_cvt_pk_bf16_f32 v176, v168, v169
    v_cvt_pk_bf16_f32 v177, v170, v171
    v_cvt_pk_bf16_f32 v178, v172, v173
    s_waitcnt lgkmcnt(6)
    v_mfma_f32_32x32x16_bf16 v[184:199], v[232:235], v[92:95], v[184:199]
    ds_read_b64_tr_b16 v[224:225], v252 offset:6144
    ds_read_b64_tr_b16 v[226:227], v252 offset:6656
    v_cvt_pk_bf16_f32 v179, v174, v175
    s_add_u32 s57, s49, 1024
    buffer_store_dwordx4 v[176:179], v16, s[24:27], s57 offen sc1
    s_waitcnt lgkmcnt(6)
    v_mfma_f32_32x32x16_bf16 v[200:215], v[236:239], v[92:95], v[200:215]
    ds_read_b64_tr_b16 v[228:229], v253 offset:6144
    ds_read_b64_tr_b16 v[230:231], v253 offset:6656
    v_xor_b32 v252, 81920, v9
    v_xor_b32 v253, 81952, v9
    s_waitcnt lgkmcnt(6)
    v_mfma_f32_32x32x16_bf16 v[184:199], v[216:219], v[96:99], v[184:199]
    ds_read_b64_tr_b16 v[232:233], v252 offset:0
    ds_read_b64_tr_b16 v[234:235], v252 offset:512
    s_waitcnt lgkmcnt(6)
    v_mfma_f32_32x32x16_bf16 v[200:215], v[220:223], v[96:99], v[200:215]
    ds_read_b64_tr_b16 v[236:237], v253 offset:0
    ds_read_b64_tr_b16 v[238:239], v253 offset:512
    s_waitcnt lgkmcnt(6)
    v_mfma_f32_32x32x16_bf16 v[184:199], v[224:227], v[100:103], v[184:199]
    ds_read_b64_tr_b16 v[216:217], v252 offset:2048
    ds_read_b64_tr_b16 v[218:219], v252 offset:2560
    s_waitcnt lgkmcnt(6)
    v_mfma_f32_32x32x16_bf16 v[200:215], v[228:231], v[100:103], v[200:215]
    ds_read_b64_tr_b16 v[220:221], v253 offset:2048
    ds_read_b64_tr_b16 v[222:223], v253 offset:2560
    s_waitcnt lgkmcnt(6)
    v_mfma_f32_32x32x16_bf16 v[184:199], v[232:235], v[104:107], v[184:199]
    ds_read_b64_tr_b16 v[224:225], v252 offset:4096
    ds_read_b64_tr_b16 v[226:227], v252 offset:4608
    s_waitcnt lgkmcnt(6)
    v_mfma_f32_32x32x16_bf16 v[200:215], v[236:239], v[104:107], v[200:215]
    ds_read_b64_tr_b16 v[228:229], v253 offset:4096
    ds_read_b64_tr_b16 v[230:231], v253 offset:4608
    s_waitcnt lgkmcnt(6)
    v_mfma_f32_32x32x16_bf16 v[184:199], v[216:219], v[108:111], v[184:199]
    ds_read_b64_tr_b16 v[232:233], v252 offset:6144
    ds_read_b64_tr_b16 v[234:235], v252 offset:6656
    s_waitcnt lgkmcnt(6)
    v_mfma_f32_32x32x16_bf16 v[200:215], v[220:223], v[108:111], v[200:215]
    ds_read_b64_tr_b16 v[236:237], v253 offset:6144
    ds_read_b64_tr_b16 v[238:239], v253 offset:6656
    v_xor_b32 v252, 98304, v9
    v_xor_b32 v253, 98336, v9
    s_waitcnt lgkmcnt(6)
    v_mfma_f32_32x32x16_bf16 v[184:199], v[224:227], v[112:115], v[184:199]
    ds_read_b64_tr_b16 v[216:217], v252 offset:0
    ds_read_b64_tr_b16 v[218:219], v252 offset:512
    s_waitcnt lgkmcnt(6)
    v_mfma_f32_32x32x16_bf16 v[200:215], v[228:231], v[112:115], v[200:215]
    ds_read_b64_tr_b16 v[220:221], v253 offset:0
    ds_read_b64_tr_b16 v[222:223], v253 offset:512
    s_waitcnt lgkmcnt(6)
    v_mfma_f32_32x32x16_bf16 v[184:199], v[232:235], v[116:119], v[184:199]
    ds_read_b64_tr_b16 v[224:225], v252 offset:2048
    ds_read_b64_tr_b16 v[226:227], v252 offset:2560
    s_waitcnt lgkmcnt(6)
    v_mfma_f32_32x32x16_bf16 v[200:215], v[236:239], v[116:119], v[200:215]
    ds_read_b64_tr_b16 v[228:229], v253 offset:2048
    ds_read_b64_tr_b16 v[230:231], v253 offset:2560
    s_waitcnt lgkmcnt(6)
    v_mfma_f32_32x32x16_bf16 v[184:199], v[216:219], v[120:123], v[184:199]
    ds_read_b64_tr_b16 v[232:233], v252 offset:4096
    ds_read_b64_tr_b16 v[234:235], v252 offset:4608
    s_waitcnt lgkmcnt(6)
    v_mfma_f32_32x32x16_bf16 v[200:215], v[220:223], v[120:123], v[200:215]
    ds_read_b64_tr_b16 v[236:237], v253 offset:4096
    ds_read_b64_tr_b16 v[238:239], v253 offset:4608
    s_waitcnt lgkmcnt(6)
    v_mfma_f32_32x32x16_bf16 v[184:199], v[224:227], v[124:127], v[184:199]
    ds_read_b64_tr_b16 v[216:217], v252 offset:6144
    ds_read_b64_tr_b16 v[218:219], v252 offset:6656
    s_waitcnt lgkmcnt(6)
    v_mfma_f32_32x32x16_bf16 v[200:215], v[228:231], v[124:127], v[200:215]
    ds_read_b64_tr_b16 v[220:221], v253 offset:6144
    ds_read_b64_tr_b16 v[222:223], v253 offset:6656
    v_xor_b32 v252, 131136, v9
    v_xor_b32 v253, 131168, v9
    s_waitcnt lgkmcnt(6)
    v_mfma_f32_32x32x16_bf16 v[184:199], v[232:235], v[128:131], v[184:199]
    ds_read_b64_tr_b16 v[224:225], v252 offset:0
    ds_read_b64_tr_b16 v[226:227], v252 offset:512
    s_waitcnt lgkmcnt(6)
    v_mfma_f32_32x32x16_bf16 v[200:215], v[236:239], v[128:131], v[200:215]
    ds_read_b64_tr_b16 v[228:229], v253 offset:0
    ds_read_b64_tr_b16 v[230:231], v253 offset:512
    s_waitcnt lgkmcnt(6)
    v_mfma_f32_32x32x16_bf16 v[184:199], v[216:219], v[132:135], v[184:199]
    ds_read_b64_tr_b16 v[232:233], v252 offset:2048
    ds_read_b64_tr_b16 v[234:235], v252 offset:2560
    s_waitcnt lgkmcnt(6)
    v_mfma_f32_32x32x16_bf16 v[200:215], v[220:223], v[132:135], v[200:215]
    ds_read_b64_tr_b16 v[236:237], v253 offset:2048
    ds_read_b64_tr_b16 v[238:239], v253 offset:2560
    s_waitcnt lgkmcnt(6)
    v_mfma_f32_32x32x16_bf16 v[152:167], v[224:227], v[24:27], 0
    ds_read_b64_tr_b16 v[216:217], v252 offset:4096
    ds_read_b64_tr_b16 v[218:219], v252 offset:4608
    s_nop 1
    v_mul_f32 v240, v184, v184
    v_mul_f32 v241, v185, v185
    v_mul_f32 v242, v186, v186
    v_mul_f32 v243, v187, v187
    s_waitcnt lgkmcnt(6)
    v_mfma_f32_32x32x16_bf16 v[168:183], v[228:231], v[24:27], 0
    ds_read_b64_tr_b16 v[220:221], v253 offset:4096
    ds_read_b64_tr_b16 v[222:223], v253 offset:4608
    v_mul_f32 v244, v188, v188
    v_mul_f32 v245, v189, v189
    v_mul_f32 v246, v190, v190
    v_mul_f32 v247, v191, v191
    s_waitcnt lgkmcnt(6)
    v_mfma_f32_32x32x16_bf16 v[152:167], v[232:235], v[28:31], v[152:167]
    ds_read_b64_tr_b16 v[224:225], v252 offset:6144
    ds_read_b64_tr_b16 v[226:227], v252 offset:6656
    v_fmamk_f32 v240, v240, 0xbdd2d3e8, v11
    v_fmamk_f32 v241, v241, 0xbdd2d3e8, v11
    v_fmamk_f32 v242, v242, 0xbdd2d3e8, v11
    v_fmamk_f32 v243, v243, 0xbdd2d3e8, v11
    s_waitcnt lgkmcnt(6)
    v_mfma_f32_32x32x16_bf16 v[168:183], v[236:239], v[28:31], v[168:183]
    ds_read_b64_tr_b16 v[228:229], v253 offset:6144
    ds_read_b64_tr_b16 v[230:231], v253 offset:6656
    v_fmamk_f32 v244, v244, 0xbdd2d3e8, v11
    v_fmamk_f32 v245, v245, 0xbdd2d3e8, v11
    v_fmamk_f32 v246, v246, 0xbdd2d3e8, v11
    v_fmamk_f32 v247, v247, 0xbdd2d3e8, v11
    v_xor_b32 v252, 16448, v9
    v_xor_b32 v253, 16480, v9
    s_waitcnt lgkmcnt(6)
    v_mfma_f32_32x32x16_bf16 v[152:167], v[216:219], v[32:35], v[152:167]
    ds_read_b64_tr_b16 v[232:233], v252 offset:0
    ds_read_b64_tr_b16 v[234:235], v252 offset:512
    v_mul_f32 v240, v240, v184
    v_mul_f32 v241, v241, v185
    v_mul_f32 v242, v242, v186
    v_mul_f32 v243, v243, v187
    s_waitcnt lgkmcnt(6)
    v_mfma_f32_32x32x16_bf16 v[168:183], v[220:223], v[32:35], v[168:183]
    ds_read_b64_tr_b16 v[236:237], v253 offset:0
    ds_read_b64_tr_b16 v[238:239], v253 offset:512
    v_mul_f32 v244, v244, v188
    v_mul_f32 v245, v245, v189
    v_mul_f32 v246, v246, v190
    v_mul_f32 v247, v247, v191
    s_waitcnt lgkmcnt(6)
    v_mfma_f32_32x32x16_bf16 v[152:167], v[224:227], v[36:39], v[152:167]
    ds_read_b64_tr_b16 v[216:217], v252 offset:2048
    ds_read_b64_tr_b16 v[218:219], v252 offset:2560
    v_exp_f32 v240, v240
    v_mul_f32 v184, v184, v192
    v_exp_f32 v241, v241
    v_mul_f32 v185, v185, v193
    s_waitcnt lgkmcnt(6)
    v_mfma_f32_32x32x16_bf16 v[168:183], v[228:231], v[36:39], v[168:183]
    ds_read_b64_tr_b16 v[220:221], v253 offset:2048
    ds_read_b64_tr_b16 v[222:223], v253 offset:2560
    v_exp_f32 v242, v242
    v_mul_f32 v186, v186, v194
    v_exp_f32 v243, v243
    v_mul_f32 v187, v187, v195
    s_waitcnt lgkmcnt(6)
    v_mfma_f32_32x32x16_bf16 v[152:167], v[232:235], v[40:43], v[152:167]
    ds_read_b64_tr_b16 v[224:225], v252 offset:4096
    ds_read_b64_tr_b16 v[226:227], v252 offset:4608
    v_exp_f32 v244, v244
    v_mul_f32 v188, v188, v196
    v_exp_f32 v245, v245
    v_mul_f32 v189, v189, v197
    s_waitcnt lgkmcnt(6)
    v_mfma_f32_32x32x16_bf16 v[168:183], v[236:239], v[40:43], v[168:183]
    ds_read_b64_tr_b16 v[228:229], v253 offset:4096
    ds_read_b64_tr_b16 v[230:231], v253 offset:4608
    v_exp_f32 v246, v246
    v_mul_f32 v190, v190, v198
    v_exp_f32 v247, v247
    v_mul_f32 v191, v191, v199
    s_waitcnt lgkmcnt(6)
    v_mfma_f32_32x32x16_bf16 v[152:167], v[216:219], v[44:47], v[152:167]
    ds_read_b64_tr_b16 v[232:233], v252 offset:6144
    ds_read_b64_tr_b16 v[234:235], v252 offset:6656
    v_add_f32 v240, 1.0, v240
    v_add_f32 v241, 1.0, v241
    v_add_f32 v242, 1.0, v242
    v_add_f32 v243, 1.0, v243
    s_waitcnt lgkmcnt(6)
    v_mfma_f32_32x32x16_bf16 v[168:183], v[220:223], v[44:47], v[168:183]
    ds_read_b64_tr_b16 v[236:237], v253 offset:6144
    ds_read_b64_tr_b16 v[238:239], v253 offset:6656
    v_add_f32 v244, 1.0, v244
    v_add_f32 v245, 1.0, v245
    v_add_f32 v246, 1.0, v246
    v_add_f32 v247, 1.0, v247
    v_xor_b32 v252, 32832, v9
    v_xor_b32 v253, 32864, v9
    s_waitcnt lgkmcnt(6)
    v_mfma_f32_32x32x16_bf16 v[152:167], v[224:227], v[48:51], v[152:167]
    ds_read_b64_tr_b16 v[216:217], v252 offset:0
    ds_read_b64_tr_b16 v[218:219], v252 offset:512
    v_rcp_f32 v240, v240
    v_rcp_f32 v241, v241
    v_rcp_f32 v242, v242
    v_rcp_f32 v243, v243
    s_waitcnt lgkmcnt(6)
    v_mfma_f32_32x32x16_bf16 v[168:183], v[228:231], v[48:51], v[168:183]
    ds_read_b64_tr_b16 v[220:221], v253 offset:0
    ds_read_b64_tr_b16 v[222:223], v253 offset:512
    v_rcp_f32 v244, v244
    v_rcp_f32 v245, v245
    v_rcp_f32 v246, v246
    v_rcp_f32 v247, v247
    s_waitcnt lgkmcnt(6)
    v_mfma_f32_32x32x16_bf16 v[152:167], v[232:235], v[52:55], v[152:167]
    ds_read_b64_tr_b16 v[224:225], v252 offset:2048
    ds_read_b64_tr_b16 v[226:227], v252 offset:2560
    v_mul_f32 v184, v184, v240
    v_mul_f32 v185, v185, v241
    v_mul_f32 v186, v186, v242
    v_mul_f32 v187, v187, v243
    s_waitcnt lgkmcnt(6)
    v_mfma_f32_32x32x16_bf16 v[168:183], v[236:239], v[52:55], v[168:183]
    ds_read_b64_tr_b16 v[228:229], v253 offset:2048
    ds_read_b64_tr_b16 v[230:231], v253 offset:2560
    v_mul_f32 v188, v188, v244
    v_mul_f32 v189, v189, v245
    v_mul_f32 v190, v190, v246
    v_mul_f32 v191, v191, v247
    s_waitcnt lgkmcnt(6)
    v_mfma_f32_32x32x16_bf16 v[152:167], v[216:219], v[56:59], v[152:167]
    ds_read_b64_tr_b16 v[232:233], v252 offset:4096
    ds_read_b64_tr_b16 v[234:235], v252 offset:4608
    v_cvt_pk_bf16_f32 v192, v184, v185
    v_cvt_pk_bf16_f32 v193, v186, v187
    v_cvt_pk_bf16_f32 v194, v188, v189
    v_cvt_pk_bf16_f32 v195, v190, v191
    s_waitcnt lgkmcnt(6)
    v_mfma_f32_32x32x16_bf16 v[168:183], v[220:223], v[56:59], v[168:183]
    ds_read_b64_tr_b16 v[236:237], v253 offset:4096
    ds_read_b64_tr_b16 v[238:239], v253 offset:4608
    s_add_u32 s57, s49, 4096
    buffer_store_dwordx4 v[192:195], v16, s[24:27], s57 offen sc1
    v_mul_f32 v240, v200, v200
    v_mul_f32 v241, v201, v201
    v_mul_f32 v242, v202, v202
    s_waitcnt lgkmcnt(6)
    v_mfma_f32_32x32x16_bf16 v[152:167], v[224:227], v[60:63], v[152:167]
    ds_read_b64_tr_b16 v[216:217], v252 offset:6144
    ds_read_b64_tr_b16 v[218:219], v252 offset:6656
    v_mul_f32 v243, v203, v203
    v_mul_f32 v244, v204, v204
    v_mul_f32 v245, v205, v205
    v_mul_f32 v246, v206, v206
    s_waitcnt lgkmcnt(6)
    v_mfma_f32_32x32x16_bf16 v[168:183], v[228:231], v[60:63], v[168:183]
    ds_read_b64_tr_b16 v[220:221], v253 offset:6144
    ds_read_b64_tr_b16 v[222:223], v253 offset:6656
    v_mul_f32 v247, v207, v207
    v_fmamk_f32 v240, v240, 0xbdd2d3e8, v11
    v_fmamk_f32 v241, v241, 0xbdd2d3e8, v11
    v_fmamk_f32 v242, v242, 0xbdd2d3e8, v11
    v_xor_b32 v252, 49216, v9
    v_xor_b32 v253, 49248, v9
    s_waitcnt lgkmcnt(6)
    v_mfma_f32_32x32x16_bf16 v[152:167], v[232:235], v[64:67], v[152:167]
    ds_read_b64_tr_b16 v[224:225], v252 offset:0
    ds_read_b64_tr_b16 v[226:227], v252 offset:512
    v_fmamk_f32 v243, v243, 0xbdd2d3e8, v11
    v_fmamk_f32 v244, v244, 0xbdd2d3e8, v11
    v_fmamk_f32 v245, v245, 0xbdd2d3e8, v11
    v_fmamk_f32 v246, v246, 0xbdd2d3e8, v11
    s_waitcnt lgkmcnt(6)
    v_mfma_f32_32x32x16_bf16 v[168:183], v[236:239], v[64:67], v[168:183]
    ds_read_b64_tr_b16 v[228:229], v253 offset:0
    ds_read_b64_tr_b16 v[230:231], v253 offset:512
    v_fmamk_f32 v247, v247, 0xbdd2d3e8, v11
    v_mul_f32 v240, v240, v200
    v_mul_f32 v241, v241, v201
    v_mul_f32 v242, v242, v202
    s_waitcnt lgkmcnt(6)
    v_mfma_f32_32x32x16_bf16 v[152:167], v[216:219], v[68:71], v[152:167]
    ds_read_b64_tr_b16 v[232:233], v252 offset:2048
    ds_read_b64_tr_b16 v[234:235], v252 offset:2560
    v_mul_f32 v243, v243, v203
    v_mul_f32 v244, v244, v204
    v_mul_f32 v245, v245, v205
    v_mul_f32 v246, v246, v206
    s_waitcnt lgkmcnt(6)
    v_mfma_f32_32x32x16_bf16 v[168:183], v[220:223], v[68:71], v[168:183]
    ds_read_b64_tr_b16 v[236:237], v253 offset:2048
    ds_read_b64_tr_b16 v[238:239], v253 offset:2560
    v_mul_f32 v247, v247, v207
    v_exp_f32 v240, v240
    v_mul_f32 v200, v200, v208
    v_exp_f32 v241, v241
    s_waitcnt lgkmcnt(6)
    v_mfma_f32_32x32x16_bf16 v[152:167], v[224:227], v[72:75], v[152:167]
    ds_read_b64_tr_b16 v[216:217], v252 offset:4096
    ds_read_b64_tr_b16 v[218:219], v252 offset:4608
    v_mul_f32 v201, v201, v209
    v_exp_f32 v242, v242
    v_mul_f32 v202, v202, v210
    v_exp_f32 v243, v243
    s_waitcnt lgkmcnt(6)
    v_mfma_f32_32x32x16_bf16 v[168:183], v[228:231], v[72:75], v[168:183]
    ds_read_b64_tr_b16 v[220:221], v253 offset:4096
    ds_read_b64_tr_b16 v[222:223], v253 offset:4608
    v_mul_f32 v203, v203, v211
    v_exp_f32 v244, v244
    v_mul_f32 v204, v204, v212
    v_exp_f32 v245, v245
    s_waitcnt lgkmcnt(6)
    v_mfma_f32_32x32x16_bf16 v[152:167], v[232:235], v[76:79], v[152:167]
    ds_read_b64_tr_b16 v[224:225], v252 offset:6144
    ds_read_b64_tr_b16 v[226:227], v252 offset:6656
    v_mul_f32 v205, v205, v213
    v_exp_f32 v246, v246
    v_mul_f32 v206, v206, v214
    v_exp_f32 v247, v247
    s_waitcnt lgkmcnt(6)
    v_mfma_f32_32x32x16_bf16 v[168:183], v[236:239], v[76:79], v[168:183]
    ds_read_b64_tr_b16 v[228:229], v253 offset:6144
    ds_read_b64_tr_b16 v[230:231], v253 offset:6656
    v_mul_f32 v207, v207, v215
    v_add_f32 v240, 1.0, v240
    v_add_f32 v241, 1.0, v241
    v_add_f32 v242, 1.0, v242
    v_xor_b32 v252, 65600, v9
    v_xor_b32 v253, 65632, v9
    s_waitcnt lgkmcnt(6)
    v_mfma_f32_32x32x16_bf16 v[152:167], v[216:219], v[80:83], v[152:167]
    ds_read_b64_tr_b16 v[232:233], v252 offset:0
    ds_read_b64_tr_b16 v[234:235], v252 offset:512
    v_add_f32 v243, 1.0, v243
    v_add_f32 v244, 1.0, v244
    v_add_f32 v245, 1.0, v245
    v_add_f32 v246, 1.0, v246
    s_waitcnt lgkmcnt(6)
    v_mfma_f32_32x32x16_bf16 v[168:183], v[220:223], v[80:83], v[168:183]
    ds_read_b64_tr_b16 v[236:237], v253 offset:0
    ds_read_b64_tr_b16 v[238:239], v253 offset:512
    v_add_f32 v247, 1.0, v247
    v_rcp_f32 v240, v240
    v_rcp_f32 v241, v241
    v_rcp_f32 v242, v242
    s_waitcnt lgkmcnt(6)
    v_mfma_f32_32x32x16_bf16 v[152:167], v[224:227], v[84:87], v[152:167]
    ds_read_b64_tr_b16 v[216:217], v252 offset:2048
    ds_read_b64_tr_b16 v[218:219], v252 offset:2560
    v_rcp_f32 v243, v243
    v_rcp_f32 v244, v244
    v_rcp_f32 v245, v245
    v_rcp_f32 v246, v246
    s_waitcnt lgkmcnt(6)
    v_mfma_f32_32x32x16_bf16 v[168:183], v[228:231], v[84:87], v[168:183]
    ds_read_b64_tr_b16 v[220:221], v253 offset:2048
    ds_read_b64_tr_b16 v[222:223], v253 offset:2560
    v_rcp_f32 v247, v247
    v_mul_f32 v200, v200, v240
    v_mul_f32 v201, v201, v241
    v_mul_f32 v202, v202, v242
    s_waitcnt lgkmcnt(6)
    v_mfma_f32_32x32x16_bf16 v[152:167], v[232:235], v[88:91], v[152:167]
    ds_read_b64_tr_b16 v[224:225], v252 offset:4096
    ds_read_b64_tr_b16 v[226:227], v252 offset:4608
    v_mul_f32 v203, v203, v243
    v_mul_f32 v204, v204, v244
    v_mul_f32 v205, v205, v245
    v_mul_f32 v206, v206, v246
    s_waitcnt lgkmcnt(6)
    v_mfma_f32_32x32x16_bf16 v[168:183], v[236:239], v[88:91], v[168:183]
    ds_read_b64_tr_b16 v[228:229], v253 offset:4096
    ds_read_b64_tr_b16 v[230:231], v253 offset:4608
    v_mul_f32 v207, v207, v247
    v_cvt_pk_bf16_f32 v208, v200, v201
    v_cvt_pk_bf16_f32 v209, v202, v203
    v_cvt_pk_bf16_f32 v210, v204, v205
    s_waitcnt lgkmcnt(6)
    v_mfma_f32_32x32x16_bf16 v[152:167], v[216:219], v[92:95], v[152:167]
    ds_read_b64_tr_b16 v[232:233], v252 offset:6144
    ds_read_b64_tr_b16 v[234:235], v252 offset:6656
    v_cvt_pk_bf16_f32 v211, v206, v207
    s_add_u32 s57, s49, 5120
    buffer_store_dwordx4 v[208:211], v16, s[24:27], s57 offen sc1
    s_lshr_b32 s71, s44, 1
    s_and_b32 s52, s44, 1
    s_waitcnt lgkmcnt(6)
    v_mfma_f32_32x32x16_bf16 v[168:183], v[220:223], v[92:95], v[168:183]
    ds_read_b64_tr_b16 v[236:237], v253 offset:6144
    ds_read_b64_tr_b16 v[238:239], v253 offset:6656
    s_lshl_b32 s51, s64, 1
    s_add_u32 s98, s51, s52
    v_lshrrev_b32 v18, 5, v1
    v_bfe_u32 v19, v1, 2, 2
    v_xor_b32 v252, 81984, v9
    v_xor_b32 v253, 82016, v9
    s_waitcnt lgkmcnt(6)
    v_mfma_f32_32x32x16_bf16 v[152:167], v[224:227], v[96:99], v[152:167]
    ds_read_b64_tr_b16 v[216:217], v252 offset:0
    ds_read_b64_tr_b16 v[218:219], v252 offset:512
    v_lshl_add_u32 v18, v18, 2, v19
    v_lshlrev_b32 v18, 7, v18
    v_and_b32 v19, 2, v19
    v_bfe_u32 v20, v1, 4, 1
    s_waitcnt lgkmcnt(6)
    v_mfma_f32_32x32x16_bf16 v[168:183], v[228:231], v[96:99], v[168:183]
    ds_read_b64_tr_b16 v[220:221], v253 offset:0
    ds_read_b64_tr_b16 v[222:223], v253 offset:512
    v_xor_b32 v19, v19, v20
    v_lshl_add_u32 v18, v19, 5, v18
    v_and_b32 v19, 3, v1
    v_lshl_add_u32 v18, v19, 3, v18
    s_waitcnt lgkmcnt(6)
    v_mfma_f32_32x32x16_bf16 v[152:167], v[232:235], v[100:103], v[152:167]
    ds_read_b64_tr_b16 v[224:225], v252 offset:2048
    ds_read_b64_tr_b16 v[226:227], v252 offset:2560
    s_lshl_b32 s50, s71, 6
    v_xor_b32 v18, s50, v18
    v_xor_b32 v19, 64, v18
    v_add_u32 v2, s66, v18
    s_waitcnt lgkmcnt(6)
    v_mfma_f32_32x32x16_bf16 v[168:183], v[236:239], v[100:103], v[168:183]
    ds_read_b64_tr_b16 v[228:229], v253 offset:2048
    ds_read_b64_tr_b16 v[230:231], v253 offset:2560
    v_add_u32 v3, s66, v19
    v_add_u32 v4, 98304, v2
    v_add_u32 v5, 98304, v3
    s_lshl_b32 s50, s71, 12
    s_waitcnt lgkmcnt(6)
    v_mfma_f32_32x32x16_bf16 v[152:167], v[216:219], v[104:107], v[152:167]
    ds_read_b64_tr_b16 v[232:233], v252 offset:4096
    ds_read_b64_tr_b16 v[234:235], v252 offset:4608
    v_add_u32 v24, s50, v18
    v_add_u32 v25, s50, v19
    v_add_u32 v26, 98304, v24
    v_add_u32 v27, 98304, v25
    s_waitcnt lgkmcnt(6)
    v_mfma_f32_32x32x16_bf16 v[168:183], v[220:223], v[104:107], v[168:183]
    ds_read_b64_tr_b16 v[236:237], v253 offset:4096
    ds_read_b64_tr_b16 v[238:239], v253 offset:4608
    s_mul_i32 s50, s44, 7
    s_lshr_b32 s50, s50, 1
    v_bfe_u32 v18, v1, 2, 2
    v_add_u32 v18, s50, v18
    s_waitcnt lgkmcnt(6)
    v_mfma_f32_32x32x16_bf16 v[152:167], v[224:227], v[108:111], v[152:167]
    ds_read_b64_tr_b16 v[216:217], v252 offset:6144
    ds_read_b64_tr_b16 v[218:219], v252 offset:6656
    v_lshlrev_b32 v18, 8, v18
    v_bfe_u32 v19, v1, 1, 1
    v_lshl_add_u32 v18, v19, 7, v18
    v_and_b32 v19, 1, v1
    s_waitcnt lgkmcnt(6)
    v_mfma_f32_32x32x16_bf16 v[168:183], v[228:231], v[108:111], v[168:183]
    ds_read_b64_tr_b16 v[220:221], v253 offset:6144
    ds_read_b64_tr_b16 v[222:223], v253 offset:6656
    v_add_u32 v19, s51, v19
    v_lshl_add_u32 v18, v19, 12, v18
    v_add_u32 v18, 15859712, v18
    s_lshl_b32 s50, s98, 4
    v_xor_b32 v252, 98368, v9
    v_xor_b32 v253, 98400, v9
    s_waitcnt lgkmcnt(6)
    v_mfma_f32_32x32x16_bf16 v[152:167], v[232:235], v[112:115], v[152:167]
    ds_read_b64_tr_b16 v[224:225], v252 offset:0
    ds_read_b64_tr_b16 v[226:227], v252 offset:512
    s_lshl_b32 s53, s71, 3
    s_add_u32 s50, s50, s53
    s_lshl_b32 s70, s50, 11
    s_add_u32 s70, s70, 13631488
    s_waitcnt lgkmcnt(6)
    v_mfma_f32_32x32x16_bf16 v[168:183], v[236:239], v[112:115], v[168:183]
    ds_read_b64_tr_b16 v[228:229], v253 offset:0
    ds_read_b64_tr_b16 v[230:231], v253 offset:512
    v_and_b32 v20, 7, v1
    v_add_u32 v19, s50, v20
    v_lshlrev_b32 v19, 7, v19
    v_add_u32 v19, 16121856, v19
    s_waitcnt lgkmcnt(6)
    v_mfma_f32_32x32x16_bf16 v[152:167], v[216:219], v[116:119], v[152:167]
    ds_read_b64_tr_b16 v[232:233], v252 offset:2048
    ds_read_b64_tr_b16 v[234:235], v252 offset:2560
    v_cmp_le_u32 vcc, 32, v1
    s_nop 1
    v_cndmask_b32 v28, v18, v19, vcc
    s_lshl_b32 s50, s98, 12
    s_add_u32 s50, s50, 15863296
    s_waitcnt lgkmcnt(6)
    v_mfma_f32_32x32x16_bf16 v[168:183], v[220:223], v[116:119], v[168:183]
    ds_read_b64_tr_b16 v[236:237], v253 offset:2048
    ds_read_b64_tr_b16 v[238:239], v253 offset:2560
    v_mov_b32 v19, s50
    v_cmp_eq_u32 vcc, 16, v1
    s_nop 1
    v_cndmask_b32 v28, v28, v19, vcc
    v_lshlrev_b32 v29, 11, v20
    s_waitcnt lgkmcnt(6)
    v_mfma_f32_32x32x16_bf16 v[152:167], v[224:227], v[120:123], v[152:167]
    ds_read_b64_tr_b16 v[216:217], v252 offset:4096
    ds_read_b64_tr_b16 v[218:219], v252 offset:4608
    v_bfe_u32 v19, v1, 3, 1
    v_lshl_add_u32 v29, v19, 10, v29
    s_mul_i32 s68, s98, 114688
    s_mul_i32 s50, s44, 28672
    s_waitcnt lgkmcnt(6)
    v_mfma_f32_32x32x16_bf16 v[168:183], v[228:231], v[120:123], v[168:183]
    ds_read_b64_tr_b16 v[220:221], v253 offset:4096
    ds_read_b64_tr_b16 v[222:223], v253 offset:4608
    s_add_u32 s50, s50, 6291456
    s_add_u32 s68, s68, s50
    s_xor_b32 s53, s98, 1
    s_mul_i32 s69, s53, 114688
    s_waitcnt lgkmcnt(6)
    v_mfma_f32_32x32x16_bf16 v[152:167], v[232:235], v[124:127], v[152:167]
    ds_read_b64_tr_b16 v[224:225], v252 offset:6144
    ds_read_b64_tr_b16 v[226:227], v252 offset:6656
    s_add_u32 s69, s69, s50
    v_add_u32 v30, s66, v16
    v_xor_b32 v31, 0x800, v30
    v_xor_b32 v32, 0x1000, v30
    s_waitcnt lgkmcnt(6)
    v_mfma_f32_32x32x16_bf16 v[168:183], v[236:239], v[124:127], v[168:183]
    ds_read_b64_tr_b16 v[228:229], v253 offset:6144
    ds_read_b64_tr_b16 v[230:231], v253 offset:6656
    s_lshl_b32 s50, s44, 2
    s_add_u32 s50, s50, 155664
    v_mov_b32 v34, s50
    v_xor_b32 v6, 4, v34
    s_waitcnt lgkmcnt(6)
    v_mfma_f32_32x32x16_bf16 v[152:167], v[216:219], v[128:131], v[152:167]
    v_xor_b32 v7, 8, v34
    v_mov_b32 v35, 1
    v_and_b32 v18, 31, v1
    s_lshl_b32 s50, s98, 5
    s_waitcnt lgkmcnt(4)
    v_mfma_f32_32x32x16_bf16 v[168:183], v[220:223], v[128:131], v[168:183]
    v_add_u32 v18, s50, v18
    v_mul_u32_u24 v18, 896, v18
    v_lshrrev_b32 v19, 5, v1
    v_lshl_add_u32 v33, v19, 4, v18
    v_mov_b32 v252, 155652
    v_mov_b32 v253, 1
    s_waitcnt lgkmcnt(0)
    s_mov_b64 exec, 1
    ds_add_u32 v252, v253
    s_mov_b64 exec, -1
    v_mfma_f32_32x32x16_bf16 v[152:167], v[224:227], v[132:135], v[152:167]
    s_lshl_b32 s55, s65, 7
    s_lshl_b32 s50, s71, 6
    s_add_u32 s55, s55, s50
    v_mfma_f32_32x32x16_bf16 v[168:183], v[228:231], v[132:135], v[168:183]
    s_nop 7
    v_mul_f32 v240, v152, v152
    v_mul_f32 v241, v153, v153
    v_mul_f32 v242, v154, v154
    v_mul_f32 v243, v155, v155
    v_mul_f32 v244, v156, v156
    v_mul_f32 v245, v157, v157
    v_mul_f32 v246, v158, v158
    v_mul_f32 v247, v159, v159
    v_fmamk_f32 v240, v240, 0xbdd2d3e8, v11
    v_fmamk_f32 v241, v241, 0xbdd2d3e8, v11
    v_fmamk_f32 v242, v242, 0xbdd2d3e8, v11
    v_fmamk_f32 v243, v243, 0xbdd2d3e8, v11
    v_fmamk_f32 v244, v244, 0xbdd2d3e8, v11
    v_fmamk_f32 v245, v245, 0xbdd2d3e8, v11
    v_fmamk_f32 v246, v246, 0xbdd2d3e8, v11
    v_fmamk_f32 v247, v247, 0xbdd2d3e8, v11
    v_mul_f32 v240, v240, v152
    v_mul_f32 v241, v241, v153
    v_mul_f32 v242, v242, v154
    v_mul_f32 v243, v243, v155
    v_mul_f32 v244, v244, v156
    v_mul_f32 v245, v245, v157
    v_mul_f32 v246, v246, v158
    v_mul_f32 v247, v247, v159
    v_exp_f32 v240, v240
    v_mul_f32 v152, v152, v160
    v_exp_f32 v241, v241
    v_mul_f32 v153, v153, v161
    v_exp_f32 v242, v242
    v_mul_f32 v154, v154, v162
    v_exp_f32 v243, v243
    v_mul_f32 v155, v155, v163
    v_exp_f32 v244, v244
    v_mul_f32 v156, v156, v164
    v_exp_f32 v245, v245
    v_mul_f32 v157, v157, v165
    v_exp_f32 v246, v246
    v_mul_f32 v158, v158, v166
    v_exp_f32 v247, v247
    v_mul_f32 v159, v159, v167
    v_add_f32 v240, 1.0, v240
    v_add_f32 v241, 1.0, v241
    v_add_f32 v242, 1.0, v242
    v_add_f32 v243, 1.0, v243
    v_add_f32 v244, 1.0, v244
    v_add_f32 v245, 1.0, v245
    v_add_f32 v246, 1.0, v246
    v_add_f32 v247, 1.0, v247
    v_rcp_f32 v240, v240
    v_rcp_f32 v241, v241
    v_rcp_f32 v242, v242
    v_rcp_f32 v243, v243
    v_rcp_f32 v244, v244
    v_rcp_f32 v245, v245
    v_rcp_f32 v246, v246
    v_rcp_f32 v247, v247
    v_mul_f32 v152, v152, v240
    v_mul_f32 v153, v153, v241
    v_mul_f32 v154, v154, v242
    v_mul_f32 v155, v155, v243
    v_mul_f32 v156, v156, v244
    v_mul_f32 v157, v157, v245
    v_mul_f32 v158, v158, v246
    v_mul_f32 v159, v159, v247
    v_cvt_pk_bf16_f32 v160, v152, v153
    v_cvt_pk_bf16_f32 v161, v154, v155
    v_cvt_pk_bf16_f32 v162, v156, v157
    v_cvt_pk_bf16_f32 v163, v158, v159
    s_add_u32 s57, s49, 2048
    buffer_store_dwordx4 v[160:163], v16, s[24:27], s57 offen sc1
    v_mul_f32 v240, v168, v168
    v_mul_f32 v241, v169, v169
    v_mul_f32 v242, v170, v170
    v_mul_f32 v243, v171, v171
    v_mul_f32 v244, v172, v172
    v_mul_f32 v245, v173, v173
    v_mul_f32 v246, v174, v174
    v_mul_f32 v247, v175, v175
    v_fmamk_f32 v240, v240, 0xbdd2d3e8, v11
    v_fmamk_f32 v241, v241, 0xbdd2d3e8, v11
    v_fmamk_f32 v242, v242, 0xbdd2d3e8, v11
    v_fmamk_f32 v243, v243, 0xbdd2d3e8, v11
    v_fmamk_f32 v244, v244, 0xbdd2d3e8, v11
    v_fmamk_f32 v245, v245, 0xbdd2d3e8, v11
    v_fmamk_f32 v246, v246, 0xbdd2d3e8, v11
    v_fmamk_f32 v247, v247, 0xbdd2d3e8, v11
    v_mul_f32 v240, v240, v168
    v_mul_f32 v241, v241, v169
    v_mul_f32 v242, v242, v170
    v_mul_f32 v243, v243, v171
    v_mul_f32 v244, v244, v172
    v_mul_f32 v245, v245, v173
    v_mul_f32 v246, v246, v174
    v_mul_f32 v247, v247, v175
    v_exp_f32 v240, v240
    v_mul_f32 v168, v168, v176
    v_exp_f32 v241, v241
    v_mul_f32 v169, v169, v177
    v_exp_f32 v242, v242
    v_mul_f32 v170, v170, v178
    v_exp_f32 v243, v243
    v_mul_f32 v171, v171, v179
    v_exp_f32 v244, v244
    v_mul_f32 v172, v172, v180
    v_exp_f32 v245, v245
    v_mul_f32 v173, v173, v181
    v_exp_f32 v246, v246
    v_mul_f32 v174, v174, v182
    v_exp_f32 v247, v247
    v_mul_f32 v175, v175, v183
    v_add_f32 v240, 1.0, v240
    v_add_f32 v241, 1.0, v241
    v_add_f32 v242, 1.0, v242
    v_add_f32 v243, 1.0, v243
    v_add_f32 v244, 1.0, v244
    v_add_f32 v245, 1.0, v245
    v_add_f32 v246, 1.0, v246
    v_add_f32 v247, 1.0, v247
    v_rcp_f32 v240, v240
    v_rcp_f32 v241, v241
    v_rcp_f32 v242, v242
    v_rcp_f32 v243, v243
    v_rcp_f32 v244, v244
    v_rcp_f32 v245, v245
    v_rcp_f32 v246, v246
    v_rcp_f32 v247, v247
    v_mul_f32 v168, v168, v240
    v_mul_f32 v169, v169, v241
    v_mul_f32 v170, v170, v242
    v_mul_f32 v171, v171, v243
    v_mul_f32 v172, v172, v244
    v_mul_f32 v173, v173, v245
    v_mul_f32 v174, v174, v246
    v_mul_f32 v175, v175, v247
    v_cvt_pk_bf16_f32 v176, v168, v169
    v_cvt_pk_bf16_f32 v177, v170, v171
    v_cvt_pk_bf16_f32 v178, v172, v173
    v_cvt_pk_bf16_f32 v179, v174, v175
    s_add_u32 s57, s49, 3072
    buffer_store_dwordx4 v[176:179], v16, s[24:27], s57 offen sc1
    v_mov_b32 v18, 155652
    s_mov_b32 s58, 0x100000
L_cnt_37:
    ds_read_b32 v19, v18
    s_waitcnt lgkmcnt(0)
    v_readfirstlane_b32 s50, v19
    s_nop 0
    s_cmp_ge_u32 s50, 8
    s_cbranch_scc1 L_cntd_38
    s_sub_u32 s58, s58, 1
    s_cmp_lg_u32 s58, 0
    s_cbranch_scc1 L_cnt_37
L_cntd_38:
    s_setprio 0
    s_add_u32 m0, s66, 0
    s_add_u32 s56, s67, 0
    buffer_load_dwordx4 v15, s[16:19], s56 offen lds
    s_add_u32 m0, s66, 1024
    s_add_u32 s56, s67, 7168
    buffer_load_dwordx4 v15, s[16:19], s56 offen lds
    s_add_u32 m0, s66, 8192
    s_add_u32 s56, s67, 14336
    buffer_load_dwordx4 v15, s[16:19], s56 offen lds
    s_add_u32 m0, s66, 9216
    s_add_u32 s56, s67, 21504
    buffer_load_dwordx4 v15, s[16:19], s56 offen lds
    s_add_u32 m0, s66, 16384
    s_add_u32 s56, s67, 28672
    buffer_load_dwordx4 v15, s[16:19], s56 offen lds
    s_add_u32 m0, s66, 17408
    s_add_u32 s56, s67, 35840
    buffer_load_dwordx4 v15, s[16:19], s56 offen lds
    s_lshl_b32 s53, s45, 4
    s_add_u32 s53, s53, s43
    s_lshl_b32 s53, s53, 8
    s_add_u32 s53, s53, 15859840
    s_waitcnt vmcnt(6)
    s_mov_b64 exec, 0xffff
    buffer_store_dwordx2 v[12:13], v14, s[24:27], s53 offen sc1
    s_mov_b64 exec, -1
    s_add_u32 m0, s66, 24576
    s_add_u32 s56, s67, 43008
    buffer_load_dwordx4 v15, s[16:19], s56 offen lds
    s_add_u32 m0, s66, 25600
    s_add_u32 s56, s67, 50176
    buffer_load_dwordx4 v15, s[16:19], s56 offen lds
    s_add_u32 m0, s66, 114688
    s_add_u32 s56, s67, 57344
    buffer_load_dwordx4 v15, s[16:19], s56 offen lds
    s_add_u32 m0, s66, 115712
    s_add_u32 s56, s67, 64512
    buffer_load_dwordx4 v15, s[16:19], s56 offen lds
    s_add_u32 m0, s66, 122880
    s_add_u32 s56, s67, 71680
    buffer_load_dwordx4 v15, s[16:19], s56 offen lds
    s_add_u32 m0, s66, 123904
    s_add_u32 s56, s67, 78848
    buffer_load_dwordx4 v15, s[16:19], s56 offen lds
    s_add_u32 m0, s66, 131072
    s_add_u32 s56, s67, 86016
    buffer_load_dwordx4 v15, s[16:19], s56 offen lds
    s_add_u32 m0, s66, 132096
    s_add_u32 s56, s67, 93184
    buffer_load_dwordx4 v15, s[16:19], s56 offen lds
    s_add_u32 m0, s66, 139264
    s_add_u32 s56, s67, 100352
    buffer_load_dwordx4 v15, s[16:19], s56 offen lds
    s_add_u32 m0, s66, 140288
    s_add_u32 s56, s67, 107520
    buffer_load_dwordx4 v15, s[16:19], s56 offen lds
    s_add_u32 m0, s66, 147456
    s_add_u32 s56, s67, 114688
    buffer_load_dwordx4 v15, s[16:19], s56 offen lds
    s_add_u32 m0, s66, 148480
    s_add_u32 s56, s67, 121856
    buffer_load_dwordx4 v15, s[16:19], s56 offen lds
    s_add_u32 m0, s66, 32768
    s_add_u32 s56, s67, 129024
    buffer_load_dwordx4 v15, s[16:19], s56 offen lds
    s_add_u32 m0, s66, 33792
    s_add_u32 s56, s67, 136192
    buffer_load_dwordx4 v15, s[16:19], s56 offen lds
    s_add_u32 m0, s66, 40960
    s_add_u32 s56, s67, 143360
    buffer_load_dwordx4 v15, s[16:19], s56 offen lds
    s_add_u32 m0, s66, 41984
    s_add_u32 s56, s67, 150528
    buffer_load_dwordx4 v15, s[16:19], s56 offen lds
    s_add_u32 m0, s66, 98304
    s_add_u32 s56, s67, 157696
    buffer_load_dwordx4 v15, s[16:19], s56 offen lds
    s_add_u32 m0, s66, 99328
    s_add_u32 s56, s67, 164864
    buffer_load_dwordx4 v15, s[16:19], s56 offen lds
    s_add_u32 m0, s66, 106496
    s_add_u32 s56, s67, 172032
    buffer_load_dwordx4 v15, s[16:19], s56 offen lds
    s_add_u32 m0, s66, 107520
    s_add_u32 s56, s67, 179200
    buffer_load_dwordx4 v15, s[16:19], s56 offen lds
    s_mov_b32 s58, 0x4000
L_poll_39:
    buffer_load_dwordx2 v[18:19], v28, s[24:27], 0 offen sc1
    s_waitcnt vmcnt(0)
    s_setprio 3
    v_cmp_ne_u64 vcc, s[60:61], v[18:19]
    s_setprio 0
    s_nop 3
    s_cbranch_vccz L_polld_40
    s_sleep 2
    s_sub_u32 s58, s58, 1
    s_cmp_lg_u32 s58, 0
    s_cbranch_scc1 L_poll_39
L_polld_40:
    s_lshl_b32 s50, s98, 7
    s_add_u32 s50, s50, 15728640
    buffer_load_dword v17, v10, s[24:27], s50 offen sc1
    buffer_load_dwordx4 v[116:119], v16, s[24:27], s68 offen offset:0 sc1
    buffer_load_dwordx4 v[120:123], v16, s[24:27], s69 offen offset:0 sc1
    buffer_load_dwordx4 v[124:127], v16, s[24:27], s68 offen offset:1024 sc1
    buffer_load_dwordx4 v[128:131], v16, s[24:27], s69 offen offset:1024 sc1
    buffer_load_dwordx4 v[132:135], v16, s[24:27], s68 offen offset:2048 sc1
    buffer_load_dwordx4 v[136:139], v16, s[24:27], s69 offen offset:2048 sc1
    buffer_load_dwordx4 v[140:143], v16, s[24:27], s68 offen offset:3072 sc1
    buffer_load_dwordx4 v[144:147], v16, s[24:27], s69 offen offset:3072 sc1
    s_add_u32 s57, s68, 4096
    buffer_load_dwordx4 v[148:151], v16, s[24:27], s57 offen offset:0 sc1
    s_add_u32 s57, s69, 4096
    buffer_load_dwordx4 v[152:155], v16, s[24:27], s57 offen offset:0 sc1
    s_add_u32 s57, s68, 4096
    buffer_load_dwordx4 v[156:159], v16, s[24:27], s57 offen offset:1024 sc1
    s_add_u32 s57, s69, 4096
    buffer_load_dwordx4 v[160:163], v16, s[24:27], s57 offen offset:1024 sc1
    s_add_u32 s57, s68, 4096
    buffer_load_dwordx4 v[164:167], v16, s[24:27], s57 offen offset:2048 sc1
    s_add_u32 s57, s69, 4096
    buffer_load_dwordx4 v[168:171], v16, s[24:27], s57 offen offset:2048 sc1
    s_add_u32 s57, s68, 4096
    buffer_load_dwordx4 v[172:175], v16, s[24:27], s57 offen offset:3072 sc1
    s_add_u32 s57, s69, 4096
    buffer_load_dwordx4 v[176:179], v16, s[24:27], s57 offen offset:3072 sc1
    s_add_u32 s57, s68, 8192
    buffer_load_dwordx4 v[180:183], v16, s[24:27], s57 offen offset:0 sc1
    s_add_u32 s57, s69, 8192
    buffer_load_dwordx4 v[184:187], v16, s[24:27], s57 offen offset:0 sc1
    s_add_u32 s57, s68, 8192
    buffer_load_dwordx4 v[188:191], v16, s[24:27], s57 offen offset:1024 sc1
    s_add_u32 s57, s69, 8192
    buffer_load_dwordx4 v[192:195], v16, s[24:27], s57 offen offset:1024 sc1
    s_add_u32 s57, s68, 8192
    buffer_load_dwordx4 v[196:199], v16, s[24:27], s57 offen offset:2048 sc1
    s_add_u32 s57, s69, 8192
    buffer_load_dwordx4 v[200:203], v16, s[24:27], s57 offen offset:2048 sc1
    s_add_u32 s57, s68, 8192
    buffer_load_dwordx4 v[204:207], v16, s[24:27], s57 offen offset:3072 sc1
    s_add_u32 s57, s69, 8192
    buffer_load_dwordx4 v[208:211], v16, s[24:27], s57 offen offset:3072 sc1
    s_add_u32 s57, s68, 12288
    buffer_load_dwordx4 v[212:215], v16, s[24:27], s57 offen offset:0 sc1
    s_add_u32 s57, s69, 12288
    buffer_load_dwordx4 v[216:219], v16, s[24:27], s57 offen offset:0 sc1
    ds_read_b64_tr_b16 v[100:101], v2 offset:0
    ds_read_b64_tr_b16 v[102:103], v2 offset:1024
    ds_read_b64_tr_b16 v[104:105], v3 offset:0
    ds_read_b64_tr_b16 v[106:107], v3 offset:1024
    s_waitcnt vmcnt(24)
    ds_read_b64_tr_b16 v[108:109], v2 offset:8192
    ds_read_b64_tr_b16 v[110:111], v2 offset:9216
    ds_read_b64_tr_b16 v[112:113], v3 offset:8192
    ds_read_b64_tr_b16 v[114:115], v3 offset:9216
    s_waitcnt lgkmcnt(4)
    v_mfma_f32_32x32x16_bf16 v[36:51], v[100:103], v[116:119], 0
    v_mfma_f32_32x32x16_bf16 v[52:67], v[104:107], v[116:119], 0
    v_mfma_f32_32x32x16_bf16 v[68:83], v[100:103], v[120:123], 0
    v_mfma_f32_32x32x16_bf16 v[84:99], v[104:107], v[120:123], 0
    s_add_u32 m0, s66, 0
    s_add_u32 s56, s67, 186368
    buffer_load_dwordx4 v15, s[16:19], s56 offen lds
    s_add_u32 m0, s66, 1024
    s_add_u32 s56, s67, 193536
    buffer_load_dwordx4 v15, s[16:19], s56 offen lds
    s_add_u32 s57, s68, 12288
    buffer_load_dwordx4 v[116:119], v16, s[24:27], s57 offen offset:1024 sc1
    s_add_u32 s57, s69, 12288
    buffer_load_dwordx4 v[120:123], v16, s[24:27], s57 offen offset:1024 sc1
    s_waitcnt vmcnt(26)
    ds_read_b64_tr_b16 v[100:101], v2 offset:16384
    ds_read_b64_tr_b16 v[102:103], v2 offset:17408
    ds_read_b64_tr_b16 v[104:105], v3 offset:16384
    ds_read_b64_tr_b16 v[106:107], v3 offset:17408
    s_waitcnt lgkmcnt(4)
    v_mfma_f32_32x32x16_bf16 v[36:51], v[108:111], v[124:127], v[36:51]
    v_mfma_f32_32x32x16_bf16 v[52:67], v[112:115], v[124:127], v[52:67]
    v_mfma_f32_32x32x16_bf16 v[68:83], v[108:111], v[128:131], v[68:83]
    v_mfma_f32_32x32x16_bf16 v[84:99], v[112:115], v[128:131], v[84:99]
    s_add_u32 m0, s66, 8192
    s_add_u32 s56, s67, 200704
    buffer_load_dwordx4 v15, s[16:19], s56 offen lds
    s_add_u32 m0, s66, 9216
    s_add_u32 s56, s67, 207872
    buffer_load_dwordx4 v15, s[16:19], s56 offen lds
    s_add_u32 s57, s68, 12288
    buffer_load_dwordx4 v[124:127], v16, s[24:27], s57 offen offset:2048 sc1
    s_add_u32 s57, s69, 12288
    buffer_load_dwordx4 v[128:131], v16, s[24:27], s57 offen offset:2048 sc1
    s_waitcnt vmcnt(28)
    ds_read_b64_tr_b16 v[108:109], v2 offset:24576
    ds_read_b64_tr_b16 v[110:111], v2 offset:25600
    ds_read_b64_tr_b16 v[112:113], v3 offset:24576
    ds_read_b64_tr_b16 v[114:115], v3 offset:25600
    s_waitcnt lgkmcnt(4)
    v_mfma_f32_32x32x16_bf16 v[36:51], v[100:103], v[132:135], v[36:51]
    v_mfma_f32_32x32x16_bf16 v[52:67], v[104:107], v[132:135], v[52:67]
    v_mfma_f32_32x32x16_bf16 v[68:83], v[100:103], v[136:139], v[68:83]
    v_mfma_f32_32x32x16_bf16 v[84:99], v[104:107], v[136:139], v[84:99]
    s_add_u32 m0, s66, 16384
    s_add_u32 s56, s67, 215040
    buffer_load_dwordx4 v15, s[16:19], s56 offen lds
    s_add_u32 m0, s66, 17408
    s_add_u32 s56, s67, 222208
    buffer_load_dwordx4 v15, s[16:19], s56 offen lds
    s_add_u32 s57, s68, 12288
    buffer_load_dwordx4 v[132:135], v16, s[24:27], s57 offen offset:3072 sc1
    s_add_u32 s57, s69, 12288
    buffer_load_dwordx4 v[136:139], v16, s[24:27], s57 offen offset:3072 sc1
    s_waitcnt vmcnt(30)
    ds_read_b64_tr_b16 v[100:101], v4 offset:16384
    ds_read_b64_tr_b16 v[102:103], v4 offset:17408
    ds_read_b64_tr_b16 v[104:105], v5 offset:16384
    ds_read_b64_tr_b16 v[106:107], v5 offset:17408
    s_waitcnt lgkmcnt(4)
    v_mfma_f32_32x32x16_bf16 v[36:51], v[108:111], v[140:143], v[36:51]
    v_mfma_f32_32x32x16_bf16 v[52:67], v[112:115], v[140:143], v[52:67]
    v_mfma_f32_32x32x16_bf16 v[68:83], v[108:111], v[144:147], v[68:83]
    v_mfma_f32_32x32x16_bf16 v[84:99], v[112:115], v[144:147], v[84:99]
    s_add_u32 m0, s66, 24576
    s_add_u32 s56, s67, 229376
    buffer_load_dwordx4 v15, s[16:19], s56 offen lds
    s_add_u32 m0, s66, 25600
    s_add_u32 s56, s67, 236544
    buffer_load_dwordx4 v15, s[16:19], s56 offen lds
    s_add_u32 s57, s68, 16384
    buffer_load_dwordx4 v[140:143], v16, s[24:27], s57 offen offset:0 sc1
    s_add_u32 s57, s69, 16384
    buffer_load_dwordx4 v[144:147], v16, s[24:27], s57 offen offset:0 sc1
    s_waitcnt vmcnt(32)
    ds_read_b64_tr_b16 v[108:109], v4 offset:24576
    ds_read_b64_tr_b16 v[110:111], v4 offset:25600
    ds_read_b64_tr_b16 v[112:113], v5 offset:24576
    ds_read_b64_tr_b16 v[114:115], v5 offset:25600
    s_waitcnt lgkmcnt(4)
    v_mfma_f32_32x32x16_bf16 v[36:51], v[100:103], v[148:151], v[36:51]
    v_mfma_f32_32x32x16_bf16 v[52:67], v[104:107], v[148:151], v[52:67]
    v_mfma_f32_32x32x16_bf16 v[68:83], v[100:103], v[152:155], v[68:83]
    v_mfma_f32_32x32x16_bf16 v[84:99], v[104:107], v[152:155], v[84:99]
    s_add_u32 m0, s66, 114688
    s_add_u32 s56, s67, 243712
    buffer_load_dwordx4 v15, s[16:19], s56 offen lds
    s_add_u32 m0, s66, 115712
    s_add_u32 s56, s67, 250880
    buffer_load_dwordx4 v15, s[16:19], s56 offen lds
    s_add_u32 s57, s68, 16384
    buffer_load_dwordx4 v[148:151], v16, s[24:27], s57 offen offset:1024 sc1
    s_add_u32 s57, s69, 16384
    buffer_load_dwordx4 v[152:155], v16, s[24:27], s57 offen offset:1024 sc1
    s_waitcnt vmcnt(34)
    ds_read_b64_tr_b16 v[100:101], v4 offset:32768
    ds_read_b64_tr_b16 v[102:103], v4 offset:33792
    ds_read_b64_tr_b16 v[104:105], v5 offset:32768
    ds_read_b64_tr_b16 v[106:107], v5 offset:33792
    s_waitcnt lgkmcnt(4)
    v_mfma_f32_32x32x16_bf16 v[36:51], v[108:111], v[156:159], v[36:51]
    v_mfma_f32_32x32x16_bf16 v[52:67], v[112:115], v[156:159], v[52:67]
    v_mfma_f32_32x32x16_bf16 v[68:83], v[108:111], v[160:163], v[68:83]
    v_mfma_f32_32x32x16_bf16 v[84:99], v[112:115], v[160:163], v[84:99]
    s_add_u32 m0, s66, 122880
    s_add_u32 s56, s67, 258048
    buffer_load_dwordx4 v15, s[16:19], s56 offen lds
    s_add_u32 m0, s66, 123904
    s_add_u32 s56, s67, 265216
    buffer_load_dwordx4 v15, s[16:19], s56 offen lds
    s_add_u32 s57, s68, 16384
    buffer_load_dwordx4 v[156:159], v16, s[24:27], s57 offen offset:2048 sc1
    s_add_u32 s57, s69, 16384
    buffer_load_dwordx4 v[160:163], v16, s[24:27], s57 offen offset:2048 sc1
    s_waitcnt vmcnt(36)
    ds_read_b64_tr_b16 v[108:109], v4 offset:40960
    ds_read_b64_tr_b16 v[110:111], v4 offset:41984
    ds_read_b64_tr_b16 v[112:113], v5 offset:40960
    ds_read_b64_tr_b16 v[114:115], v5 offset:41984
    s_waitcnt lgkmcnt(4)
    v_mfma_f32_32x32x16_bf16 v[36:51], v[100:103], v[164:167], v[36:51]
    v_mfma_f32_32x32x16_bf16 v[52:67], v[104:107], v[164:167], v[52:67]
    v_mfma_f32_32x32x16_bf16 v[68:83], v[100:103], v[168:171], v[68:83]
    v_mfma_f32_32x32x16_bf16 v[84:99], v[104:107], v[168:171], v[84:99]
    s_add_u32 m0, s66, 131072
    s_add_u32 s56, s67, 272384
    buffer_load_dwordx4 v15, s[16:19], s56 offen lds
    s_add_u32 m0, s66, 132096
    s_add_u32 s56, s67, 279552
    buffer_load_dwordx4 v15, s[16:19], s56 offen lds
    s_add_u32 s57, s68, 16384
    buffer_load_dwordx4 v[164:167], v16, s[24:27], s57 offen offset:3072 sc1
    s_add_u32 s57, s69, 16384
    buffer_load_dwordx4 v[168:171], v16, s[24:27], s57 offen offset:3072 sc1
    s_waitcnt vmcnt(38)
    ds_read_b64_tr_b16 v[100:101], v4 offset:49152
    ds_read_b64_tr_b16 v[102:103], v4 offset:50176
    ds_read_b64_tr_b16 v[104:105], v5 offset:49152
    ds_read_b64_tr_b16 v[106:107], v5 offset:50176
    s_waitcnt lgkmcnt(4)
    v_mfma_f32_32x32x16_bf16 v[36:51], v[108:111], v[172:175], v[36:51]
    v_mfma_f32_32x32x16_bf16 v[52:67], v[112:115], v[172:175], v[52:67]
    v_mfma_f32_32x32x16_bf16 v[68:83], v[108:111], v[176:179], v[68:83]
    v_mfma_f32_32x32x16_bf16 v[84:99], v[112:115], v[176:179], v[84:99]
    s_add_u32 m0, s66, 139264
    s_add_u32 s56, s67, 286720
    buffer_load_dwordx4 v15, s[16:19], s56 offen lds
    s_add_u32 m0, s66, 140288
    s_add_u32 s56, s67, 293888
    buffer_load_dwordx4 v15, s[16:19], s56 offen lds
    s_add_u32 s57, s68, 20480
    buffer_load_dwordx4 v[172:175], v16, s[24:27], s57 offen offset:0 sc1
    s_add_u32 s57, s69, 20480
    buffer_load_dwordx4 v[176:179], v16, s[24:27], s57 offen offset:0 sc1
    s_waitcnt vmcnt(40)
    ds_read_b64_tr_b16 v[108:109], v2 offset:32768
    ds_read_b64_tr_b16 v[110:111], v2 offset:33792
    ds_read_b64_tr_b16 v[112:113], v3 offset:32768
    ds_read_b64_tr_b16 v[114:115], v3 offset:33792
    s_waitcnt lgkmcnt(4)
    v_mfma_f32_32x32x16_bf16 v[36:51], v[100:103], v[180:183], v[36:51]
    v_mfma_f32_32x32x16_bf16 v[52:67], v[104:107], v[180:183], v[52:67]
    v_mfma_f32_32x32x16_bf16 v[68:83], v[100:103], v[184:187], v[68:83]
    v_mfma_f32_32x32x16_bf16 v[84:99], v[104:107], v[184:187], v[84:99]
    s_add_u32 m0, s66, 147456
    s_add_u32 s56, s67, 301056
    buffer_load_dwordx4 v15, s[16:19], s56 offen lds
    s_add_u32 m0, s66, 148480
    s_add_u32 s56, s67, 308224
    buffer_load_dwordx4 v15, s[16:19], s56 offen lds
    s_add_u32 s57, s68, 20480
    buffer_load_dwordx4 v[180:183], v16, s[24:27], s57 offen offset:1024 sc1
    s_add_u32 s57, s69, 20480
    buffer_load_dwordx4 v[184:187], v16, s[24:27], s57 offen offset:1024 sc1
    s_waitcnt vmcnt(42)
    ds_read_b64_tr_b16 v[100:101], v2 offset:40960
    ds_read_b64_tr_b16 v[102:103], v2 offset:41984
    ds_read_b64_tr_b16 v[104:105], v3 offset:40960
    ds_read_b64_tr_b16 v[106:107], v3 offset:41984
    s_waitcnt lgkmcnt(4)
    v_mfma_f32_32x32x16_bf16 v[36:51], v[108:111], v[188:191], v[36:51]
    v_mfma_f32_32x32x16_bf16 v[52:67], v[112:115], v[188:191], v[52:67]
    v_mfma_f32_32x32x16_bf16 v[68:83], v[108:111], v[192:195], v[68:83]
    v_mfma_f32_32x32x16_bf16 v[84:99], v[112:115], v[192:195], v[84:99]
    s_add_u32 m0, s66, 32768
    s_add_u32 s56, s67, 315392
    buffer_load_dwordx4 v15, s[16:19], s56 offen lds
    s_add_u32 m0, s66, 33792
    s_add_u32 s56, s67, 322560
    buffer_load_dwordx4 v15, s[16:19], s56 offen lds
    s_add_u32 s57, s68, 20480
    buffer_load_dwordx4 v[188:191], v16, s[24:27], s57 offen offset:2048 sc1
    s_add_u32 s57, s69, 20480
    buffer_load_dwordx4 v[192:195], v16, s[24:27], s57 offen offset:2048 sc1
    s_waitcnt vmcnt(44)
    ds_read_b64_tr_b16 v[108:109], v4 offset:0
    ds_read_b64_tr_b16 v[110:111], v4 offset:1024
    ds_read_b64_tr_b16 v[112:113], v5 offset:0
    ds_read_b64_tr_b16 v[114:115], v5 offset:1024
    s_waitcnt lgkmcnt(4)
    v_mfma_f32_32x32x16_bf16 v[36:51], v[100:103], v[196:199], v[36:51]
    v_mfma_f32_32x32x16_bf16 v[52:67], v[104:107], v[196:199], v[52:67]
    v_mfma_f32_32x32x16_bf16 v[68:83], v[100:103], v[200:203], v[68:83]
    v_mfma_f32_32x32x16_bf16 v[84:99], v[104:107], v[200:203], v[84:99]
    s_add_u32 m0, s66, 40960
    s_add_u32 s56, s67, 329728
    buffer_load_dwordx4 v15, s[16:19], s56 offen lds
    s_add_u32 m0, s66, 41984
    s_add_u32 s56, s67, 336896
    buffer_load_dwordx4 v15, s[16:19], s56 offen lds
    s_add_u32 s57, s68, 20480
    buffer_load_dwordx4 v[196:199], v16, s[24:27], s57 offen offset:3072 sc1
    s_add_u32 s57, s69, 20480
    buffer_load_dwordx4 v[200:203], v16, s[24:27], s57 offen offset:3072 sc1
    s_waitcnt vmcnt(46)
    ds_read_b64_tr_b16 v[100:101], v4 offset:8192
    ds_read_b64_tr_b16 v[102:103], v4 offset:9216
    ds_read_b64_tr_b16 v[104:105], v5 offset:8192
    ds_read_b64_tr_b16 v[106:107], v5 offset:9216
    s_waitcnt lgkmcnt(4)
    v_mfma_f32_32x32x16_bf16 v[36:51], v[108:111], v[204:207], v[36:51]
    v_mfma_f32_32x32x16_bf16 v[52:67], v[112:115], v[204:207], v[52:67]
    v_mfma_f32_32x32x16_bf16 v[68:83], v[108:111], v[208:211], v[68:83]
    v_mfma_f32_32x32x16_bf16 v[84:99], v[112:115], v[208:211], v[84:99]
    s_add_u32 m0, s66, 98304
    s_add_u32 s56, s67, 344064
    buffer_load_dwordx4 v15, s[16:19], s56 offen lds
    s_add_u32 m0, s66, 99328
    s_add_u32 s56, s67, 351232
    buffer_load_dwordx4 v15, s[16:19], s56 offen lds
    s_add_u32 s57, s68, 24576
    buffer_load_dwordx4 v[204:207], v16, s[24:27], s57 offen offset:0 sc1
    s_add_u32 s57, s69, 24576
    buffer_load_dwordx4 v[208:211], v16, s[24:27], s57 offen offset:0 sc1
    s_waitcnt vmcnt(46)
    ds_read_b64_tr_b16 v[108:109], v2 offset:0
    ds_read_b64_tr_b16 v[110:111], v2 offset:1024
    ds_read_b64_tr_b16 v[112:113], v3 offset:0
    ds_read_b64_tr_b16 v[114:115], v3 offset:1024
    s_waitcnt lgkmcnt(4)
    v_mfma_f32_32x32x16_bf16 v[36:51], v[100:103], v[212:215], v[36:51]
    v_mfma_f32_32x32x16_bf16 v[52:67], v[104:107], v[212:215], v[52:67]
    v_mfma_f32_32x32x16_bf16 v[68:83], v[100:103], v[216:219], v[68:83]
    v_mfma_f32_32x32x16_bf16 v[84:99], v[104:107], v[216:219], v[84:99]
    s_add_u32 m0, s66, 106496
    s_add_u32 s56, s67, 358400
    buffer_load_dwordx4 v15, s[16:19], s56 offen lds
    s_add_u32 m0, s66, 107520
    s_add_u32 s56, s67, 365568
    buffer_load_dwordx4 v15, s[16:19], s56 offen lds
    s_add_u32 s57, s68, 24576
    buffer_load_dwordx4 v[212:215], v16, s[24:27], s57 offen offset:1024 sc1
    s_add_u32 s57, s69, 24576
    buffer_load_dwordx4 v[216:219], v16, s[24:27], s57 offen offset:1024 sc1
    s_waitcnt vmcnt(46)
    ds_read_b64_tr_b16 v[100:101], v2 offset:8192
    ds_read_b64_tr_b16 v[102:103], v2 offset:9216
    ds_read_b64_tr_b16 v[104:105], v3 offset:8192
    ds_read_b64_tr_b16 v[106:107], v3 offset:9216
    s_waitcnt lgkmcnt(4)
    v_mfma_f32_32x32x16_bf16 v[36:51], v[108:111], v[116:119], v[36:51]
    v_mfma_f32_32x32x16_bf16 v[52:67], v[112:115], v[116:119], v[52:67]
    v_mfma_f32_32x32x16_bf16 v[68:83], v[108:111], v[120:123], v[68:83]
    v_mfma_f32_32x32x16_bf16 v[84:99], v[112:115], v[120:123], v[84:99]
    s_add_u32 m0, s66, 0
    s_add_u32 s56, s67, 372736
    buffer_load_dwordx4 v15, s[16:19], s56 offen lds
    s_add_u32 m0, s66, 1024
    s_add_u32 s56, s67, 379904
    buffer_load_dwordx4 v15, s[16:19], s56 offen lds
    s_add_u32 s57, s68, 24576
    buffer_load_dwordx4 v[116:119], v16, s[24:27], s57 offen offset:2048 sc1
    s_add_u32 s57, s69, 24576
    buffer_load_dwordx4 v[120:123], v16, s[24:27], s57 offen offset:2048 sc1
    s_waitcnt vmcnt(46)
    ds_read_b64_tr_b16 v[108:109], v2 offset:16384
    ds_read_b64_tr_b16 v[110:111], v2 offset:17408
    ds_read_b64_tr_b16 v[112:113], v3 offset:16384
    ds_read_b64_tr_b16 v[114:115], v3 offset:17408
    s_waitcnt lgkmcnt(4)
    v_mfma_f32_32x32x16_bf16 v[36:51], v[100:103], v[124:127], v[36:51]
    v_mfma_f32_32x32x16_bf16 v[52:67], v[104:107], v[124:127], v[52:67]
    v_mfma_f32_32x32x16_bf16 v[68:83], v[100:103], v[128:131], v[68:83]
    v_mfma_f32_32x32x16_bf16 v[84:99], v[104:107], v[128:131], v[84:99]
    s_add_u32 m0, s66, 8192
    s_add_u32 s56, s67, 387072
    buffer_load_dwordx4 v15, s[16:19], s56 offen lds
    s_add_u32 m0, s66, 9216
    s_add_u32 s56, s67, 394240
    buffer_load_dwordx4 v15, s[16:19], s56 offen lds
    s_add_u32 s57, s68, 24576
    buffer_load_dwordx4 v[124:127], v16, s[24:27], s57 offen offset:3072 sc1
    s_add_u32 s57, s69, 24576
    buffer_load_dwordx4 v[128:131], v16, s[24:27], s57 offen offset:3072 sc1
    s_waitcnt vmcnt(46)
    ds_read_b64_tr_b16 v[100:101], v2 offset:24576
    ds_read_b64_tr_b16 v[102:103], v2 offset:25600
    ds_read_b64_tr_b16 v[104:105], v3 offset:24576
    ds_read_b64_tr_b16 v[106:107], v3 offset:25600
    s_waitcnt lgkmcnt(4)
    v_mfma_f32_32x32x16_bf16 v[36:51], v[108:111], v[132:135], v[36:51]
    v_mfma_f32_32x32x16_bf16 v[52:67], v[112:115], v[132:135], v[52:67]
    v_mfma_f32_32x32x16_bf16 v[68:83], v[108:111], v[136:139], v[68:83]
    v_mfma_f32_32x32x16_bf16 v[84:99], v[112:115], v[136:139], v[84:99]
    s_add_u32 m0, s66, 16384
    s_add_u32 s56, s62, 0
    buffer_load_dwordx4 v15, s[20:23], s56 offen lds
    s_add_u32 m0, s66, 17408
    s_add_u32 s56, s62, 7168
    buffer_load_dwordx4 v15, s[20:23], s56 offen lds
    s_waitcnt vmcnt(44)
    ds_read_b64_tr_b16 v[108:109], v4 offset:16384
    ds_read_b64_tr_b16 v[110:111], v4 offset:17408
    ds_read_b64_tr_b16 v[112:113], v5 offset:16384
    ds_read_b64_tr_b16 v[114:115], v5 offset:17408
    s_waitcnt lgkmcnt(4)
    v_mfma_f32_32x32x16_bf16 v[36:51], v[100:103], v[140:143], v[36:51]
    v_mfma_f32_32x32x16_bf16 v[52:67], v[104:107], v[140:143], v[52:67]
    v_mfma_f32_32x32x16_bf16 v[68:83], v[100:103], v[144:147], v[68:83]
    v_mfma_f32_32x32x16_bf16 v[84:99], v[104:107], v[144:147], v[84:99]
    s_add_u32 m0, s66, 24576
    s_add_u32 s56, s62, 14336
    buffer_load_dwordx4 v15, s[20:23], s56 offen lds
    s_add_u32 m0, s66, 25600
    s_add_u32 s56, s62, 21504
    buffer_load_dwordx4 v15, s[20:23], s56 offen lds
    s_waitcnt vmcnt(42)
    ds_read_b64_tr_b16 v[100:101], v4 offset:24576
    ds_read_b64_tr_b16 v[102:103], v4 offset:25600
    ds_read_b64_tr_b16 v[104:105], v5 offset:24576
    ds_read_b64_tr_b16 v[106:107], v5 offset:25600
    s_waitcnt lgkmcnt(4)
    v_mfma_f32_32x32x16_bf16 v[36:51], v[108:111], v[148:151], v[36:51]
    v_mfma_f32_32x32x16_bf16 v[52:67], v[112:115], v[148:151], v[52:67]
    v_mfma_f32_32x32x16_bf16 v[68:83], v[108:111], v[152:155], v[68:83]
    v_mfma_f32_32x32x16_bf16 v[84:99], v[112:115], v[152:155], v[84:99]
    s_add_u32 m0, s66, 114688
    s_add_u32 s56, s62, 25088
    buffer_load_dwordx4 v15, s[20:23], s56 offen lds
    s_add_u32 m0, s66, 115712
    s_add_u32 s56, s62, 32256
    buffer_load_dwordx4 v15, s[20:23], s56 offen lds
    s_waitcnt vmcnt(40)
    ds_read_b64_tr_b16 v[108:109], v4 offset:32768
    ds_read_b64_tr_b16 v[110:111], v4 offset:33792
    ds_read_b64_tr_b16 v[112:113], v5 offset:32768
    ds_read_b64_tr_b16 v[114:115], v5 offset:33792
    s_waitcnt lgkmcnt(4)
    v_mfma_f32_32x32x16_bf16 v[36:51], v[100:103], v[156:159], v[36:51]
    v_mfma_f32_32x32x16_bf16 v[52:67], v[104:107], v[156:159], v[52:67]
    v_mfma_f32_32x32x16_bf16 v[68:83], v[100:103], v[160:163], v[68:83]
    v_mfma_f32_32x32x16_bf16 v[84:99], v[104:107], v[160:163], v[84:99]
    s_add_u32 m0, s66, 122880
    s_add_u32 s56, s62, 39424
    buffer_load_dwordx4 v15, s[20:23], s56 offen lds
    s_add_u32 m0, s66, 123904
    s_add_u32 s56, s62, 46592
    buffer_load_dwordx4 v15, s[20:23], s56 offen lds
    s_waitcnt vmcnt(38)
    ds_read_b64_tr_b16 v[100:101], v4 offset:40960
    ds_read_b64_tr_b16 v[102:103], v4 offset:41984
    ds_read_b64_tr_b16 v[104:105], v5 offset:40960
    ds_read_b64_tr_b16 v[106:107], v5 offset:41984
    s_waitcnt lgkmcnt(4)
    v_mfma_f32_32x32x16_bf16 v[36:51], v[108:111], v[164:167], v[36:51]
    v_mfma_f32_32x32x16_bf16 v[52:67], v[112:115], v[164:167], v[52:67]
    v_mfma_f32_32x32x16_bf16 v[68:83], v[108:111], v[168:171], v[68:83]
    v_mfma_f32_32x32x16_bf16 v[84:99], v[112:115], v[168:171], v[84:99]
    s_add_u32 m0, s66, 131072
    s_add_u32 s56, s62, 50176
    buffer_load_dwordx4 v15, s[20:23], s56 offen lds
    s_add_u32 m0, s66, 132096
    s_add_u32 s56, s62, 57344
    buffer_load_dwordx4 v15, s[20:23], s56 offen lds
    s_waitcnt vmcnt(36)
    ds_read_b64_tr_b16 v[108:109], v4 offset:49152
    ds_read_b64_tr_b16 v[110:111], v4 offset:50176
    ds_read_b64_tr_b16 v[112:113], v5 offset:49152
    ds_read_b64_tr_b16 v[114:115], v5 offset:50176
    s_waitcnt lgkmcnt(4)
    v_mfma_f32_32x32x16_bf16 v[36:51], v[100:103], v[172:175], v[36:51]
    v_mfma_f32_32x32x16_bf16 v[52:67], v[104:107], v[172:175], v[52:67]
    v_mfma_f32_32x32x16_bf16 v[68:83], v[100:103], v[176:179], v[68:83]
    v_mfma_f32_32x32x16_bf16 v[84:99], v[104:107], v[176:179], v[84:99]
    s_add_u32 m0, s66, 139264
    s_add_u32 s56, s62, 64512
    buffer_load_dwordx4 v15, s[20:23], s56 offen lds
    s_add_u32 m0, s66, 140288
    s_add_u32 s56, s62, 71680
    buffer_load_dwordx4 v15, s[20:23], s56 offen lds
    s_waitcnt vmcnt(34)
    ds_read_b64_tr_b16 v[100:101], v2 offset:32768
    ds_read_b64_tr_b16 v[102:103], v2 offset:33792
    ds_read_b64_tr_b16 v[104:105], v3 offset:32768
    ds_read_b64_tr_b16 v[106:107], v3 offset:33792
    s_waitcnt lgkmcnt(4)
    v_mfma_f32_32x32x16_bf16 v[36:51], v[108:111], v[180:183], v[36:51]
    v_mfma_f32_32x32x16_bf16 v[52:67], v[112:115], v[180:183], v[52:67]
    v_mfma_f32_32x32x16_bf16 v[68:83], v[108:111], v[184:187], v[68:83]
    v_mfma_f32_32x32x16_bf16 v[84:99], v[112:115], v[184:187], v[84:99]
    s_add_u32 m0, s66, 147456
    s_add_u32 s56, s62, 75264
    buffer_load_dwordx4 v15, s[20:23], s56 offen lds
    s_add_u32 m0, s66, 148480
    s_add_u32 s56, s62, 82432
    buffer_load_dwordx4 v15, s[20:23], s56 offen lds
    s_waitcnt vmcnt(32)
    ds_read_b64_tr_b16 v[108:109], v2 offset:40960
    ds_read_b64_tr_b16 v[110:111], v2 offset:41984
    ds_read_b64_tr_b16 v[112:113], v3 offset:40960
    ds_read_b64_tr_b16 v[114:115], v3 offset:41984
    s_waitcnt lgkmcnt(4)
    v_mfma_f32_32x32x16_bf16 v[36:51], v[100:103], v[188:191], v[36:51]
    v_mfma_f32_32x32x16_bf16 v[52:67], v[104:107], v[188:191], v[52:67]
    v_mfma_f32_32x32x16_bf16 v[68:83], v[100:103], v[192:195], v[68:83]
    v_mfma_f32_32x32x16_bf16 v[84:99], v[104:107], v[192:195], v[84:99]
    s_add_u32 m0, s66, 32768
    s_add_u32 s56, s62, 89600
    buffer_load_dwordx4 v15, s[20:23], s56 offen lds
    s_add_u32 m0, s66, 33792
    s_add_u32 s56, s62, 96768
    buffer_load_dwordx4 v15, s[20:23], s56 offen lds
    s_waitcnt vmcnt(30)
    ds_read_b64_tr_b16 v[100:101], v4 offset:0
    ds_read_b64_tr_b16 v[102:103], v4 offset:1024
    ds_read_b64_tr_b16 v[104:105], v5 offset:0
    ds_read_b64_tr_b16 v[106:107], v5 offset:1024
    s_waitcnt lgkmcnt(4)
    v_mfma_f32_32x32x16_bf16 v[36:51], v[108:111], v[196:199], v[36:51]
    v_mfma_f32_32x32x16_bf16 v[52:67], v[112:115], v[196:199], v[52:67]
    v_mfma_f32_32x32x16_bf16 v[68:83], v[108:111], v[200:203], v[68:83]
    v_mfma_f32_32x32x16_bf16 v[84:99], v[112:115], v[200:203], v[84:99]
    s_waitcnt vmcnt(26)
    ds_read_b64_tr_b16 v[108:109], v4 offset:8192
    ds_read_b64_tr_b16 v[110:111], v4 offset:9216
    ds_read_b64_tr_b16 v[112:113], v5 offset:8192
    ds_read_b64_tr_b16 v[114:115], v5 offset:9216
    s_waitcnt lgkmcnt(4)
    v_mfma_f32_32x32x16_bf16 v[36:51], v[100:103], v[204:207], v[36:51]
    v_mfma_f32_32x32x16_bf16 v[52:67], v[104:107], v[204:207], v[52:67]
    v_mfma_f32_32x32x16_bf16 v[68:83], v[100:103], v[208:211], v[68:83]
    v_mfma_f32_32x32x16_bf16 v[84:99], v[104:107], v[208:211], v[84:99]
    s_waitcnt vmcnt(22)
    ds_read_b64_tr_b16 v[100:101], v2 offset:0
    ds_read_b64_tr_b16 v[102:103], v2 offset:1024
    ds_read_b64_tr_b16 v[104:105], v3 offset:0
    ds_read_b64_tr_b16 v[106:107], v3 offset:1024
    s_waitcnt lgkmcnt(4)
    v_mfma_f32_32x32x16_bf16 v[36:51], v[108:111], v[212:215], v[36:51]
    v_mfma_f32_32x32x16_bf16 v[52:67], v[112:115], v[212:215], v[52:67]
    v_mfma_f32_32x32x16_bf16 v[68:83], v[108:111], v[216:219], v[68:83]
    v_mfma_f32_32x32x16_bf16 v[84:99], v[112:115], v[216:219], v[84:99]
    s_waitcnt vmcnt(18)
    ds_read_b64_tr_b16 v[108:109], v2 offset:8192
    ds_read_b64_tr_b16 v[110:111], v2 offset:9216
    ds_read_b64_tr_b16 v[112:113], v3 offset:8192
    ds_read_b64_tr_b16 v[114:115], v3 offset:9216
    s_waitcnt lgkmcnt(4)
    v_mfma_f32_32x32x16_bf16 v[36:51], v[100:103], v[116:119], v[36:51]
    v_mfma_f32_32x32x16_bf16 v[52:67], v[104:107], v[116:119], v[52:67]
    v_mfma_f32_32x32x16_bf16 v[68:83], v[100:103], v[120:123], v[68:83]
    v_mfma_f32_32x32x16_bf16 v[84:99], v[104:107], v[120:123], v[84:99]
    s_waitcnt vmcnt(16) lgkmcnt(0)
    v_mfma_f32_32x32x16_bf16 v[36:51], v[108:111], v[124:127], v[36:51]
    v_mfma_f32_32x32x16_bf16 v[52:67], v[112:115], v[124:127], v[52:67]
    v_mfma_f32_32x32x16_bf16 v[68:83], v[108:111], v[128:131], v[68:83]
    v_mfma_f32_32x32x16_bf16 v[84:99], v[112:115], v[128:131], v[84:99]
    s_setprio 3
    v_add_u32 v22, 98304, v30
    v_add_u32 v23, 98304, v31
    s_setprio 0
    s_nop 6
    ds_write_b128 v30, v[68:71] offset:0
    ds_write_b128 v30, v[72:75] offset:1024
    ds_write_b128 v30, v[76:79] offset:8192
    ds_write_b128 v30, v[80:83] offset:9216
    ds_write_b128 v22, v[84:87] offset:0
    ds_write_b128 v22, v[88:91] offset:1024
    ds_write_b128 v22, v[92:95] offset:8192
    ds_write_b128 v22, v[96:99] offset:9216
    s_waitcnt vmcnt(0)
    s_waitcnt lgkmcnt(0)
    ds_write_b32 v34, v35 offset:0
    s_mov_b32 s58, 0x100000
L_pw_41:
    ds_read_b32 v8, v6 offset:0
    s_waitcnt lgkmcnt(0)
    s_setprio 3
    v_readfirstlane_b32 s50, v8
    s_setprio 0
    s_cmp_lg_u32 s50, 0
    s_cbranch_scc1 L_pwd_42
    s_sleep 2
    s_sub_u32 s58, s58, 1
    s_cmp_lg_u32 s58, 0
    s_cbranch_scc1 L_pw_41
L_pwd_42:
    ds_read_b128 v[220:223], v31 offset:0
    ds_read_b128 v[224:227], v31 offset:1024
    ds_read_b128 v[228:231], v31 offset:8192
    ds_read_b128 v[232:235], v31 offset:9216
    ds_read_b128 v[236:239], v23 offset:0
    ds_read_b128 v[240:243], v23 offset:1024
    ds_read_b128 v[244:247], v23 offset:8192
    ds_read_b128 v[248:251], v23 offset:9216
    ds_read_b64_tr_b16 v[68:69], v24 offset:16384
    ds_read_b64_tr_b16 v[70:71], v24 offset:17408
    ds_read_b64_tr_b16 v[72:73], v25 offset:16384
    ds_read_b64_tr_b16 v[74:75], v25 offset:17408
    ds_read_b64_tr_b16 v[76:77], v24 offset:24576
    ds_read_b64_tr_b16 v[78:79], v24 offset:25600
    ds_read_b64_tr_b16 v[80:81], v25 offset:24576
    ds_read_b64_tr_b16 v[82:83], v25 offset:25600
    ds_read_b64_tr_b16 v[84:85], v26 offset:16384
    ds_read_b64_tr_b16 v[86:87], v26 offset:17408
    ds_read_b64_tr_b16 v[88:89], v27 offset:16384
    ds_read_b64_tr_b16 v[90:91], v27 offset:17408
    ds_read_b64_tr_b16 v[92:93], v26 offset:24576
    ds_read_b64_tr_b16 v[94:95], v26 offset:25600
    ds_read_b64_tr_b16 v[96:97], v27 offset:24576
    ds_read_b64_tr_b16 v[98:99], v27 offset:25600
    ds_read_b64_tr_b16 v[100:101], v26 offset:32768
    ds_read_b64_tr_b16 v[102:103], v26 offset:33792
    ds_read_b64_tr_b16 v[104:105], v27 offset:32768
    ds_read_b64_tr_b16 v[106:107], v27 offset:33792
    ds_read_b64_tr_b16 v[108:109], v26 offset:40960
    ds_read_b64_tr_b16 v[110:111], v26 offset:41984
    ds_read_b64_tr_b16 v[112:113], v27 offset:40960
    ds_read_b64_tr_b16 v[114:115], v27 offset:41984
    ds_read_b64_tr_b16 v[116:117], v26 offset:49152
    ds_read_b64_tr_b16 v[118:119], v26 offset:50176
    ds_read_b64_tr_b16 v[120:121], v27 offset:49152
    ds_read_b64_tr_b16 v[122:123], v27 offset:50176
    ds_read_b64_tr_b16 v[124:125], v24 offset:32768
    ds_read_b64_tr_b16 v[126:127], v24 offset:33792
    ds_read_b64_tr_b16 v[128:129], v25 offset:32768
    ds_read_b64_tr_b16 v[130:131], v25 offset:33792
    ds_read_b64_tr_b16 v[132:133], v24 offset:18432
    ds_read_b64_tr_b16 v[134:135], v24 offset:19456
    ds_read_b64_tr_b16 v[136:137], v25 offset:18432
    ds_read_b64_tr_b16 v[138:139], v25 offset:19456
    ds_read_b64_tr_b16 v[140:141], v24 offset:26624
    ds_read_b64_tr_b16 v[142:143], v24 offset:27648
    ds_read_b64_tr_b16 v[144:145], v25 offset:26624
    ds_read_b64_tr_b16 v[146:147], v25 offset:27648
    ds_read_b64_tr_b16 v[148:149], v26 offset:18432
    ds_read_b64_tr_b16 v[150:151], v26 offset:19456
    ds_read_b64_tr_b16 v[152:153], v27 offset:18432
    ds_read_b64_tr_b16 v[154:155], v27 offset:19456
    ds_read_b64_tr_b16 v[156:157], v26 offset:26624
    ds_read_b64_tr_b16 v[158:159], v26 offset:27648
    ds_read_b64_tr_b16 v[160:161], v27 offset:26624
    ds_read_b64_tr_b16 v[162:163], v27 offset:27648
    ds_read_b64_tr_b16 v[164:165], v26 offset:34816
    ds_read_b64_tr_b16 v[166:167], v26 offset:35840
    ds_read_b64_tr_b16 v[168:169], v27 offset:34816
    ds_read_b64_tr_b16 v[170:171], v27 offset:35840
    ds_read_b64_tr_b16 v[172:173], v26 offset:43008
    ds_read_b64_tr_b16 v[174:175], v26 offset:44032
    ds_read_b64_tr_b16 v[176:177], v27 offset:43008
    ds_read_b64_tr_b16 v[178:179], v27 offset:44032
    ds_read_b64_tr_b16 v[180:181], v26 offset:51200
    ds_read_b64_tr_b16 v[182:183], v26 offset:52224
    ds_read_b64_tr_b16 v[184:185], v27 offset:51200
    ds_read_b64_tr_b16 v[186:187], v27 offset:52224
    ds_read_b64_tr_b16 v[188:189], v24 offset:34816
    ds_read_b64_tr_b16 v[190:191], v24 offset:35840
    ds_read_b64_tr_b16 v[192:193], v25 offset:34816
    ds_read_b64_tr_b16 v[194:195], v25 offset:35840
    s_waitcnt lgkmcnt(0)
    ds_write_b32 v34, v35 offset:16
    s_setprio 3
    v_sub_f32 v17, 1.0, v17
    v_add_f32 v36, v36, v220
    v_add_f32 v37, v37, v221
    v_add_f32 v38, v38, v222
    v_add_f32 v39, v39, v223
    v_add_f32 v40, v40, v224
    v_add_f32 v41, v41, v225
    v_add_f32 v42, v42, v226
    v_add_f32 v43, v43, v227
    v_add_f32 v44, v44, v228
    v_add_f32 v45, v45, v229
    v_add_f32 v46, v46, v230
    v_add_f32 v47, v47, v231
    v_add_f32 v48, v48, v232
    v_add_f32 v49, v49, v233
    v_add_f32 v50, v50, v234
    v_add_f32 v51, v51, v235
    v_add_f32 v52, v52, v236
    v_add_f32 v53, v53, v237
    v_add_f32 v54, v54, v238
    v_add_f32 v55, v55, v239
    v_add_f32 v56, v56, v240
    v_add_f32 v57, v57, v241
    v_add_f32 v58, v58, v242
    v_add_f32 v59, v59, v243
    v_add_f32 v60, v60, v244
    v_add_f32 v61, v61, v245
    v_add_f32 v62, v62, v246
    v_add_f32 v63, v63, v247
    v_add_f32 v64, v64, v248
    v_add_f32 v65, v65, v249
    v_add_f32 v66, v66, v250
    v_add_f32 v67, v67, v251
    v_mul_f32 v36, v36, v17
    v_mul_f32 v37, v37, v17
    v_mul_f32 v38, v38, v17
    v_mul_f32 v39, v39, v17
    v_mul_f32 v40, v40, v17
    v_mul_f32 v41, v41, v17
    v_mul_f32 v42, v42, v17
    v_mul_f32 v43, v43, v17
    v_mul_f32 v44, v44, v17
    v_mul_f32 v45, v45, v17
    v_mul_f32 v46, v46, v17
    v_mul_f32 v47, v47, v17
    v_mul_f32 v48, v48, v17
    v_mul_f32 v49, v49, v17
    v_mul_f32 v50, v50, v17
    v_mul_f32 v51, v51, v17
    v_mul_f32 v52, v52, v17
    v_mul_f32 v53, v53, v17
    v_mul_f32 v54, v54, v17
    v_mul_f32 v55, v55, v17
    v_mul_f32 v56, v56, v17
    v_mul_f32 v57, v57, v17
    v_mul_f32 v58, v58, v17
    v_mul_f32 v59, v59, v17
    v_mul_f32 v60, v60, v17
    v_mul_f32 v61, v61, v17
    v_mul_f32 v62, v62, v17
    v_mul_f32 v63, v63, v17
    v_mul_f32 v64, v64, v17
    v_mul_f32 v65, v65, v17
    v_mul_f32 v66, v66, v17
    v_mul_f32 v67, v67, v17
    s_setprio 0
    s_mov_b32 s58, 0x100000
L_pw_43:
    ds_read_b32 v8, v6 offset:16
    s_waitcnt lgkmcnt(0)
    s_setprio 3
    v_readfirstlane_b32 s50, v8
    s_setprio 3
    s_cmp_lg_u32 s50, 0
    s_cbranch_scc1 L_pwd_44
    s_sleep 2
    s_sub_u32 s58, s58, 1
    s_cmp_lg_u32 s58, 0
    s_cbranch_scc1 L_pw_43
L_pwd_44:
    s_movk_i32 s99, 0xff
    s_mov_b32 s59, 0
    s_mov_b32 s63, 0
    s_setprio 0
    s_mov_b32 s58, 0x8000
    v_mov_b32 v18, 155660
L_ow_45:
    ds_read_b32 v19, v18
    s_waitcnt lgkmcnt(0)
    v_readfirstlane_b32 s50, v19
    s_nop 0
    s_cmp_ge_u32 s50, 4
    s_cbranch_scc1 L_owd_46
    s_sleep 1
    s_sub_u32 s58, s58, 1
    s_cmp_lg_u32 s58, 0
    s_cbranch_scc1 L_ow_45
L_owd_46:
    s_movk_i32 s63, 0xff
    s_mov_b32 s58, 0x8000
L_oround:
    s_cmp_eq_u32 s63, 0
    s_cbranch_scc1 L_oprobe
    s_bitcmp1_b32 s63, 0
    s_cbranch_scc0 L_ol_47
    s_add_u32 s57, s70, 0
    buffer_load_dwordx4 v[196:199], v16, s[24:27], s57 offen offset:0 sc1
    buffer_load_dwordx4 v[200:203], v16, s[24:27], s57 offen offset:1024 sc1
L_ol_47:
    s_bitcmp1_b32 s63, 1
    s_cbranch_scc0 L_ol_48
    s_add_u32 s57, s70, 2048
    buffer_load_dwordx4 v[204:207], v16, s[24:27], s57 offen offset:0 sc1
    buffer_load_dwordx4 v[208:211], v16, s[24:27], s57 offen offset:1024 sc1
L_ol_48:
    s_bitcmp1_b32 s63, 2
    s_cbranch_scc0 L_ol_49
    s_add_u32 s57, s70, 4096
    buffer_load_dwordx4 v[212:215], v16, s[24:27], s57 offen offset:0 sc1
    buffer_load_dwordx4 v[216:219], v16, s[24:27], s57 offen offset:1024 sc1
L_ol_49:
    s_bitcmp1_b32 s63, 3
    s_cbranch_scc0 L_ol_50
    s_add_u32 s57, s70, 6144
    buffer_load_dwordx4 v[220:223], v16, s[24:27], s57 offen offset:0 sc1
    buffer_load_dwordx4 v[224:227], v16, s[24:27], s57 offen offset:1024 sc1
L_ol_50:
    s_bitcmp1_b32 s63, 4
    s_cbranch_scc0 L_ol_51
    s_add_u32 s57, s70, 8192
    buffer_load_dwordx4 v[228:231], v16, s[24:27], s57 offen offset:0 sc1
    buffer_load_dwordx4 v[232:235], v16, s[24:27], s57 offen offset:1024 sc1
L_ol_51:
    s_bitcmp1_b32 s63, 5
    s_cbranch_scc0 L_ol_52
    s_add_u32 s57, s70, 10240
    buffer_load_dwordx4 v[236:239], v16, s[24:27], s57 offen offset:0 sc1
    buffer_load_dwordx4 v[240:243], v16, s[24:27], s57 offen offset:1024 sc1
L_ol_52:
    s_bitcmp1_b32 s63, 6
    s_cbranch_scc0 L_ol_53
    s_add_u32 s57, s70, 12288
    buffer_load_dwordx4 v[244:247], v16, s[24:27], s57 offen offset:0 sc1
    buffer_load_dwordx4 v[248:251], v16, s[24:27], s57 offen offset:1024 sc1
L_ol_53:
    s_bitcmp1_b32 s63, 7
    s_cbranch_scc0 L_ol_54
    s_add_u32 s57, s70, 14336
    buffer_load_dwordx4 v[252:255], v16, s[24:27], s57 offen offset:0 sc1
    buffer_load_dwordx4 v[8:11], v16, s[24:27], s57 offen offset:1024 sc1
L_ol_54:
    s_waitcnt vmcnt(0)
    s_bitcmp1_b32 s63, 0
    s_cbranch_scc0 L_om_55
    v_max3_u32 v18, v196, v197, v198
    v_max3_u32 v19, v199, v200, v201
    v_max3_u32 v18, v18, v202, v203
    v_max_u32 v18, v18, v19
    v_cmp_eq_u32 vcc, -1, v18
    s_nop 4
    s_cbranch_vccnz L_om_55
    s_bitset0_b32 s99, 0
L_om_55:
    s_cmp_lg_u32 s59, 0
    s_cbranch_scc1 L_oa_56
    s_bitcmp1_b32 s99, 0
    s_cbranch_scc1 L_oa_56
    v_mfma_f32_32x32x16_bf16 v[52:67], v[72:75], v[196:199], v[52:67]
    v_mfma_f32_32x32x16_bf16 v[36:51], v[68:71], v[196:199], v[36:51]
    v_mfma_f32_32x32x16_bf16 v[52:67], v[80:83], v[200:203], v[52:67]
    v_mfma_f32_32x32x16_bf16 v[36:51], v[76:79], v[200:203], v[36:51]
    s_mov_b32 s59, 1
L_oa_56:
    s_bitcmp1_b32 s63, 1
    s_cbranch_scc0 L_om_57
    v_max3_u32 v18, v204, v205, v206
    v_max3_u32 v19, v207, v208, v209
    v_max3_u32 v18, v18, v210, v211
    v_max_u32 v18, v18, v19
    v_cmp_eq_u32 vcc, -1, v18
    s_nop 4
    s_cbranch_vccnz L_om_57
    s_bitset0_b32 s99, 1
L_om_57:
    s_cmp_lg_u32 s59, 1
    s_cbranch_scc1 L_oa_58
    s_bitcmp1_b32 s99, 1
    s_cbranch_scc1 L_oa_58
    v_mfma_f32_32x32x16_bf16 v[52:67], v[88:91], v[204:207], v[52:67]
    v_mfma_f32_32x32x16_bf16 v[36:51], v[84:87], v[204:207], v[36:51]
    v_mfma_f32_32x32x16_bf16 v[52:67], v[96:99], v[208:211], v[52:67]
    v_mfma_f32_32x32x16_bf16 v[36:51], v[92:95], v[208:211], v[36:51]
    s_mov_b32 s59, 2
L_oa_58:
    s_bitcmp1_b32 s63, 2
    s_cbranch_scc0 L_om_59
    v_max3_u32 v18, v212, v213, v214
    v_max3_u32 v19, v215, v216, v217
    v_max3_u32 v18, v18, v218, v219
    v_max_u32 v18, v18, v19
    v_cmp_eq_u32 vcc, -1, v18
    s_nop 4
    s_cbranch_vccnz L_om_59
    s_bitset0_b32 s99, 2
L_om_59:
    s_cmp_lg_u32 s59, 2
    s_cbranch_scc1 L_oa_60
    s_bitcmp1_b32 s99, 2
    s_cbranch_scc1 L_oa_60
    v_mfma_f32_32x32x16_bf16 v[52:67], v[104:107], v[212:215], v[52:67]
    v_mfma_f32_32x32x16_bf16 v[36:51], v[100:103], v[212:215], v[36:51]
    v_mfma_f32_32x32x16_bf16 v[52:67], v[112:115], v[216:219], v[52:67]
    v_mfma_f32_32x32x16_bf16 v[36:51], v[108:111], v[216:219], v[36:51]
    s_mov_b32 s59, 3
L_oa_60:
    s_bitcmp1_b32 s63, 3
    s_cbranch_scc0 L_om_61
    v_max3_u32 v18, v220, v221, v222
    v_max3_u32 v19, v223, v224, v225
    v_max3_u32 v18, v18, v226, v227
    v_max_u32 v18, v18, v19
    v_cmp_eq_u32 vcc, -1, v18
    s_nop 4
    s_cbranch_vccnz L_om_61
    s_bitset0_b32 s99, 3
L_om_61:
    s_cmp_lg_u32 s59, 3
    s_cbranch_scc1 L_oa_62
    s_bitcmp1_b32 s99, 3
    s_cbranch_scc1 L_oa_62
    v_mfma_f32_32x32x16_bf16 v[52:67], v[120:123], v[220:223], v[52:67]
    v_mfma_f32_32x32x16_bf16 v[36:51], v[116:119], v[220:223], v[36:51]
    v_mfma_f32_32x32x16_bf16 v[52:67], v[128:131], v[224:227], v[52:67]
    v_mfma_f32_32x32x16_bf16 v[36:51], v[124:127], v[224:227], v[36:51]
    s_mov_b32 s59, 4
L_oa_62:
    s_bitcmp1_b32 s63, 4
    s_cbranch_scc0 L_om_63
    v_max3_u32 v18, v228, v229, v230
    v_max3_u32 v19, v231, v232, v233
    v_max3_u32 v18, v18, v234, v235
    v_max_u32 v18, v18, v19
    v_cmp_eq_u32 vcc, -1, v18
    s_nop 4
    s_cbranch_vccnz L_om_63
    s_bitset0_b32 s99, 4
L_om_63:
    s_cmp_lg_u32 s59, 4
    s_cbranch_scc1 L_oa_64
    s_bitcmp1_b32 s99, 4
    s_cbranch_scc1 L_oa_64
    v_mfma_f32_32x32x16_bf16 v[52:67], v[136:139], v[228:231], v[52:67]
    v_mfma_f32_32x32x16_bf16 v[36:51], v[132:135], v[228:231], v[36:51]
    v_mfma_f32_32x32x16_bf16 v[52:67], v[144:147], v[232:235], v[52:67]
    v_mfma_f32_32x32x16_bf16 v[36:51], v[140:143], v[232:235], v[36:51]
    s_mov_b32 s59, 5
L_oa_64:
    s_bitcmp1_b32 s63, 5
    s_cbranch_scc0 L_om_65
    v_max3_u32 v18, v236, v237, v238
    v_max3_u32 v19, v239, v240, v241
    v_max3_u32 v18, v18, v242, v243
    v_max_u32 v18, v18, v19
    v_cmp_eq_u32 vcc, -1, v18
    s_nop 4
    s_cbranch_vccnz L_om_65
    s_bitset0_b32 s99, 5
L_om_65:
    s_cmp_lg_u32 s59, 5
    s_cbranch_scc1 L_oa_66
    s_bitcmp1_b32 s99, 5
    s_cbranch_scc1 L_oa_66
    v_mfma_f32_32x32x16_bf16 v[52:67], v[152:155], v[236:239], v[52:67]
    v_mfma_f32_32x32x16_bf16 v[36:51], v[148:151], v[236:239], v[36:51]
    v_mfma_f32_32x32x16_bf16 v[52:67], v[160:163], v[240:243], v[52:67]
    v_mfma_f32_32x32x16_bf16 v[36:51], v[156:159], v[240:243], v[36:51]
    s_mov_b32 s59, 6
L_oa_66:
    s_bitcmp1_b32 s63, 6
    s_cbranch_scc0 L_om_67
    v_max3_u32 v18, v244, v245, v246
    v_max3_u32 v19, v247, v248, v249
    v_max3_u32 v18, v18, v250, v251
    v_max_u32 v18, v18, v19
    v_cmp_eq_u32 vcc, -1, v18
    s_nop 4
    s_cbranch_vccnz L_om_67
    s_bitset0_b32 s99, 6
L_om_67:
    s_cmp_lg_u32 s59, 6
    s_cbranch_scc1 L_oa_68
    s_bitcmp1_b32 s99, 6
    s_cbranch_scc1 L_oa_68
    v_mfma_f32_32x32x16_bf16 v[52:67], v[168:171], v[244:247], v[52:67]
    v_mfma_f32_32x32x16_bf16 v[36:51], v[164:167], v[244:247], v[36:51]
    v_mfma_f32_32x32x16_bf16 v[52:67], v[176:179], v[248:251], v[52:67]
    v_mfma_f32_32x32x16_bf16 v[36:51], v[172:175], v[248:251], v[36:51]
    s_mov_b32 s59, 7
L_oa_68:
    s_bitcmp1_b32 s63, 7
    s_cbranch_scc0 L_om_69
    v_max3_u32 v18, v252, v253, v254
    v_max3_u32 v19, v255, v8, v9
    v_max3_u32 v18, v18, v10, v11
    v_max_u32 v18, v18, v19
    v_cmp_eq_u32 vcc, -1, v18
    s_nop 4
    s_cbranch_vccnz L_om_69
    s_bitset0_b32 s99, 7
L_om_69:
    s_cmp_lg_u32 s59, 7
    s_cbranch_scc1 L_oa_70
    s_bitcmp1_b32 s99, 7
    s_cbranch_scc1 L_oa_70
    v_mfma_f32_32x32x16_bf16 v[52:67], v[184:187], v[252:255], v[52:67]
    v_mfma_f32_32x32x16_bf16 v[36:51], v[180:183], v[252:255], v[36:51]
    v_mfma_f32_32x32x16_bf16 v[52:67], v[192:195], v[8:11], v[52:67]
    v_mfma_f32_32x32x16_bf16 v[36:51], v[188:191], v[8:11], v[36:51]
    s_mov_b32 s59, 8
L_oa_70:
    s_cmp_eq_u32 s99, 0
    s_cbranch_scc1 L_odone
L_oprobe:
    s_waitcnt vmcnt(0)
    s_setprio 3
    v_cmp_ne_u32 vcc, -1, v20
    s_setprio 3
    s_lshr_b32 s50, vcc_lo, 8
    s_and_b32 s50, s50, vcc_lo
    s_bcnt1_i32_b32 s51, s99
    s_cmp_le_u32 s51, 8
    s_cselect_b32 s50, -1, s50
    s_and_b32 s63, s50, s99
    s_cbranch_scc1 L_onext
    s_sleep 2
L_onext:
    s_sub_u32 s58, s58, 1
    s_cmp_lg_u32 s58, 0
    s_cbranch_scc1 L_oround
L_odone:
    s_nop 7
    s_nop 1
    ds_write_b128 v30, v[52:55] offset:0
    ds_write_b128 v30, v[56:59] offset:1024
    ds_write_b128 v30, v[60:63] offset:8192
    ds_write_b128 v30, v[64:67] offset:9216
    s_waitcnt lgkmcnt(0)
    ds_write_b32 v34, v35 offset:32
    s_nop 3
    s_mov_b32 s58, 0x100000
L_pw_71:
    ds_read_b32 v8, v7 offset:32
    s_waitcnt lgkmcnt(0)
    s_setprio 3
    v_readfirstlane_b32 s50, v8
    s_setprio 3
    s_cmp_lg_u32 s50, 0
    s_cbranch_scc1 L_pwd_72
    s_sub_u32 s58, s58, 1
    s_cmp_lg_u32 s58, 0
    s_cbranch_scc1 L_pw_71
L_pwd_72:
    ds_read_b128 v[68:71], v32 offset:0
    ds_read_b128 v[72:75], v32 offset:1024
    ds_read_b128 v[76:79], v32 offset:8192
    ds_read_b128 v[80:83], v32 offset:9216
    s_waitcnt lgkmcnt(3)
    v_add_f32 v36, v36, v68
    v_add_f32 v37, v37, v69
    v_add_f32 v38, v38, v70
    v_add_f32 v39, v39, v71
    v_cvt_pk_bf16_f32 v52, v36, v37
    v_cvt_pk_bf16_f32 v53, v38, v39
    s_waitcnt lgkmcnt(2)
    v_add_f32 v40, v40, v72
    v_add_f32 v41, v41, v73
    v_add_f32 v42, v42, v74
    v_add_f32 v43, v43, v75
    v_cvt_pk_bf16_f32 v54, v40, v41
    v_cvt_pk_bf16_f32 v55, v42, v43
    s_waitcnt lgkmcnt(1)
    v_add_f32 v44, v44, v76
    v_add_f32 v45, v45, v77
    v_add_f32 v46, v46, v78
    v_add_f32 v47, v47, v79
    v_cvt_pk_bf16_f32 v56, v44, v45
    v_cvt_pk_bf16_f32 v57, v46, v47
    s_waitcnt lgkmcnt(0)
    v_add_f32 v48, v48, v80
    v_add_f32 v49, v49, v81
    v_add_f32 v50, v50, v82
    v_add_f32 v51, v51, v83
    v_cvt_pk_bf16_f32 v58, v48, v49
    v_cvt_pk_bf16_f32 v59, v50, v51
    v_permlane32_swap_b32 v52, v54
    v_permlane32_swap_b32 v53, v55
    v_permlane32_swap_b32 v56, v58
    v_permlane32_swap_b32 v57, v59
    buffer_store_dwordx4 v[52:55], v33, s[28:31], s55 offen
    buffer_store_dwordx4 v[56:59], v33, s[28:31], s55 offen offset:32
    s_endpgm
L_v:
    s_and_b32 s55, s40, 1
    v_lshrrev_b32 v18, 5, v1
    s_lshl_b32 s51, s3, 2
    v_add_u32 v19, s51, v18
    v_mul_u32_u24 v19, 2688, v19
    v_bfe_u32 v20, v1, 1, 4
    v_lshlrev_b32 v18, 1, v18
    v_xor_b32 v20, v20, v18
    v_lshl_add_u32 v19, v20, 5, v19
    v_and_b32 v21, 1, v1
    v_lshl_add_u32 v19, v21, 4, v19
    v_xor_b32 v20, 4, v20
    v_lshlrev_b32 v18, 5, v20
    v_xor_b32 v20, 4, v20
    v_lshlrev_b32 v20, 5, v20
    v_sub_u32 v18, v18, v20
    s_mul_i32 s51, s55, 384
    s_add_u32 s51, s51, 1792
    v_add_u32 v4, s51, v19
    v_add_u32 v5, v4, v18
    v_add_u32 v5, 5376, v5
    s_waitcnt lgkmcnt(0)
    s_mov_b32 s4, s72
    s_mov_b32 s5, s73
    s_mov_b32 s6, 1835008
    s_mov_b32 s7, 0x00020000
    s_mov_b32 s8, s74
    s_mov_b32 s9, s75
    s_mov_b32 s10, 1204224
    s_mov_b32 s11, 0x00020000
    s_mov_b32 s36, s86
    s_mov_b32 s37, s87
    s_mov_b32 s38, 896
    s_mov_b32 s39, 0x00020000
    v_lshlrev_b32 v16, 4, v1
    s_mov_b32 m0, 156672
    s_nop 0
    buffer_load_dwordx4 v16, s[36:39], 0 offen lds
    s_add_u32 m0, s47, 0
    s_movk_i32 s56, 0
    buffer_load_dwordx4 v2, s[4:7], s56 offen lds
    s_add_u32 m0, s47, 1024
    s_movk_i32 s56, 0
    buffer_load_dwordx4 v3, s[4:7], s56 offen lds
    s_add_u32 m0, s47, 16384
    s_mov_b32 s56, 0
    buffer_load_dwordx4 v4, s[8:11], s56 offen lds
    s_add_u32 m0, s47, 17408
    s_mov_b32 s56, 0
    buffer_load_dwordx4 v5, s[8:11], s56 offen lds
    s_barrier
    s_add_u32 m0, s47, 32768
    s_mov_b32 s56, 86016
    buffer_load_dwordx4 v4, s[8:11], s56 offen lds
    s_add_u32 m0, s47, 33792
    s_mov_b32 s56, 86016
    buffer_load_dwordx4 v5, s[8:11], s56 offen lds
    s_add_u32 m0, s47, 49152
    s_movk_i32 s56, 128
    buffer_load_dwordx4 v2, s[4:7], s56 offen lds
    s_add_u32 m0, s47, 50176
    s_movk_i32 s56, 128
    buffer_load_dwordx4 v3, s[4:7], s56 offen lds
    s_add_u32 m0, s47, 65536
    s_mov_b32 s56, 172032
    buffer_load_dwordx4 v4, s[8:11], s56 offen lds
    s_add_u32 m0, s47, 66560
    s_mov_b32 s56, 172032
    buffer_load_dwordx4 v5, s[8:11], s56 offen lds
    s_lshr_b32 s54, s41, 4
    s_lshl_b32 s62, s40, 1
    s_add_u32 s62, s62, s54
    s_and_b32 s63, s41, 15
    s_lshl_b32 s45, s42, 2
    s_add_u32 s45, s45, s44
    s_mov_b32 s20, s76
    s_mov_b32 s21, s77
    s_mov_b32 s22, 401408
    s_mov_b32 s23, 0x00020000
    s_mov_b32 s16, s84
    s_mov_b32 s17, s85
    s_mov_b32 s18, 1605632
    s_mov_b32 s19, 0x00020000
    s_mov_b32 s28, s88
    s_mov_b32 s29, s89
    s_mov_b32 s30, 1835008
    s_mov_b32 s31, 0x00020000
    s_mov_b32 s32, s90
    s_mov_b32 s33, s91
    s_mov_b32 s34, 256
    s_mov_b32 s35, 0x00020000
    s_mov_b32 s24, s92
    s_mov_b32 s25, s93
    s_mov_b32 s26, 16777216
    s_mov_b32 s27, 0x00020000
    v_lshlrev_b32 v16, 4, v1
    s_or_b32 s49, s2, s3
    s_memrealtime s[60:61]
    s_waitcnt lgkmcnt(0)
    s_or_b32 s61, s61, 0x80000000
    v_mov_b32 v12, s60
    v_mov_b32 v13, s61
    v_lshlrev_b32 v14, 3, v1
    s_cmp_eq_u32 s49, 0
    s_cselect_b32 s51, 0, 0x1000
    s_mov_b64 exec, 0xffff
    buffer_store_dwordx2 v[12:13], v14, s[32:35], s51 offen sc1
    s_mov_b64 exec, -1
    v_lshrrev_b32 v18, 5, v1
    v_bfe_u32 v19, v1, 4, 1
    v_bfe_u32 v20, v1, 2, 2
    v_and_b32 v21, 3, v1
    v_and_b32 v22, 31, v1
    v_lshlrev_b32 v10, 2, v22
    s_lshl_b32 s51, s44, 5
    v_add_u32 v22, s51, v22
    v_lshlrev_b32 v22, 7, v22
    v_bfe_u32 v23, v1, 1, 3
    v_xor_b32 v23, v23, v18
    v_lshl_add_u32 v6, v23, 4, v22
    v_lshl_add_u32 v22, v18, 3, v20
    v_lshlrev_b32 v9, 4, v18
    v_add_u32 v9, 156672, v9
    v_lshlrev_b32 v22, 9, v22
    v_lshl_add_u32 v22, v21, 3, v22
    v_lshlrev_b32 v23, 1, v20
    v_xor_b32 v23, v23, v19
    v_lshl_add_u32 v22, v23, 5, v22
    s_lshl_b32 s51, s48, 2
    s_mul_i32 s43, s55, 7
    s_add_u32 s43, s43, s51
    s_add_u32 s51, s51, s55
    s_add_u32 s52, s51, 0
    s_lshl_b32 s52, s52, 6
    v_xor_b32 v248, s52, v22
    s_add_u32 s52, s51, 1
    s_lshl_b32 s52, s52, 6
    v_xor_b32 v249, s52, v22
    s_add_u32 s52, s51, 2
    s_lshl_b32 s52, s52, 6
    v_xor_b32 v250, s52, v22
    s_add_u32 s52, s51, 3
    s_lshl_b32 s52, s52, 6
    v_xor_b32 v251, s52, v22
    s_cmp_ge_u32 s3, 4
    s_cbranch_scc1 L_v_hi
    v_lshrrev_b32 v15, 5, v1
    v_mul_u32_u24 v15, 6656, v15
    v_add_u32 v15, v15, v16
    s_waitcnt vmcnt(7)
    s_barrier
    v_add_u32 v252, 16384, v248
    v_add_u32 v253, 16384, v249
    v_add_u32 v254, 16384, v250
    v_add_u32 v255, 16384, v251
    v_xor_b32 v7, 0, v6
    ds_read_b128 v[24:27], v7
    ds_read_b64_tr_b16 v[200:201], v252 offset:0
    ds_read_b64_tr_b16 v[202:203], v252 offset:2048
    ds_read_b64_tr_b16 v[204:205], v253 offset:0
    ds_read_b64_tr_b16 v[206:207], v253 offset:2048
    ds_read_b64_tr_b16 v[208:209], v254 offset:0
    ds_read_b64_tr_b16 v[210:211], v254 offset:2048
    ds_read_b64_tr_b16 v[212:213], v255 offset:0
    ds_read_b64_tr_b16 v[214:215], v255 offset:2048
    v_xor_b32 v7, 32, v6
    ds_read_b128 v[28:31], v7
    s_add_u32 m0, s47, 81920
    s_mov_b32 s56, 258048
    buffer_load_dwordx4 v4, s[8:11], s56 offen lds
    s_add_u32 m0, s47, 82944
    s_mov_b32 s56, 258048
    buffer_load_dwordx4 v5, s[8:11], s56 offen lds
    v_xor_b32 v7, 64, v6
    ds_read_b128 v[32:35], v7
    v_xor_b32 v7, 96, v6
    ds_read_b128 v[36:39], v7
    ds_read_b64_tr_b16 v[216:217], v252 offset:8192
    ds_read_b64_tr_b16 v[218:219], v252 offset:10240
    ds_read_b64_tr_b16 v[220:221], v253 offset:8192
    ds_read_b64_tr_b16 v[222:223], v253 offset:10240
    ds_read_b64_tr_b16 v[224:225], v254 offset:8192
    ds_read_b64_tr_b16 v[226:227], v254 offset:10240
    ds_read_b64_tr_b16 v[228:229], v255 offset:8192
    ds_read_b64_tr_b16 v[230:231], v255 offset:10240
    s_add_u32 m0, s47, 98304
    s_movk_i32 s56, 256
    buffer_load_dwordx4 v2, s[4:7], s56 offen lds
    s_add_u32 m0, s47, 99328
    s_movk_i32 s56, 256
    buffer_load_dwordx4 v3, s[4:7], s56 offen lds
    s_waitcnt vmcnt(9)
    s_barrier
    v_add_u32 v252, 32768, v248
    v_add_u32 v253, 32768, v249
    v_add_u32 v254, 32768, v250
    v_add_u32 v255, 32768, v251
    s_cmp_lg_u32 s3, 0
    s_cbranch_scc1 L_cinit_73
    v_lshlrev_b32 v18, 2, v1
    v_add_u32 v18, 155648, v18
    v_cmp_eq_u32 vcc, 1, v1
    s_nop 1
    v_cndmask_b32 v19, 0, 8, vcc
    ds_write_b32 v18, v19
L_cinit_73:
    s_waitcnt lgkmcnt(15)
    v_mfma_f32_32x32x16_bf16 v[136:151], v[24:27], v[200:203], 0
    ds_read_b64_tr_b16 v[232:233], v252 offset:0
    ds_read_b64_tr_b16 v[234:235], v252 offset:2048
    s_add_u32 m0, s47, 114688
    s_mov_b32 s56, 344064
    buffer_load_dwordx4 v4, s[8:11], s56 offen lds
    v_mfma_f32_32x32x16_bf16 v[152:167], v[24:27], v[204:207], 0
    ds_read_b64_tr_b16 v[236:237], v253 offset:0
    ds_read_b64_tr_b16 v[238:239], v253 offset:2048
    s_add_u32 m0, s47, 115712
    s_mov_b32 s56, 344064
    buffer_load_dwordx4 v5, s[8:11], s56 offen lds
    s_waitcnt lgkmcnt(15)
    v_mfma_f32_32x32x16_bf16 v[168:183], v[24:27], v[208:211], 0
    ds_read_b64_tr_b16 v[240:241], v254 offset:0
    ds_read_b64_tr_b16 v[242:243], v254 offset:2048
    v_mfma_f32_32x32x16_bf16 v[184:199], v[24:27], v[212:215], 0
    ds_read_b64_tr_b16 v[244:245], v255 offset:0
    ds_read_b64_tr_b16 v[246:247], v255 offset:2048
    s_add_u32 m0, s47, 131072
    s_mov_b32 s56, 430080
    buffer_load_dwordx4 v4, s[8:11], s56 offen lds
    s_waitcnt lgkmcnt(14)
    v_mfma_f32_32x32x16_bf16 v[136:151], v[28:31], v[216:219], v[136:151]
    ds_read_b64_tr_b16 v[200:201], v252 offset:8192
    ds_read_b64_tr_b16 v[202:203], v252 offset:10240
    s_add_u32 m0, s47, 132096
    s_mov_b32 s56, 430080
    buffer_load_dwordx4 v5, s[8:11], s56 offen lds
    s_waitcnt lgkmcnt(14)
    v_mfma_f32_32x32x16_bf16 v[152:167], v[28:31], v[220:223], v[152:167]
    ds_read_b64_tr_b16 v[204:205], v253 offset:8192
    ds_read_b64_tr_b16 v[206:207], v253 offset:10240
    s_waitcnt lgkmcnt(14)
    v_mfma_f32_32x32x16_bf16 v[168:183], v[28:31], v[224:227], v[168:183]
    ds_read_b64_tr_b16 v[208:209], v254 offset:8192
    ds_read_b64_tr_b16 v[210:211], v254 offset:10240
    s_waitcnt lgkmcnt(14)
    v_mfma_f32_32x32x16_bf16 v[184:199], v[28:31], v[228:231], v[184:199]
    ds_read_b64_tr_b16 v[212:213], v255 offset:8192
    ds_read_b64_tr_b16 v[214:215], v255 offset:10240
    s_waitcnt vmcnt(9)
    s_barrier
    v_add_u32 v252, 65536, v248
    v_add_u32 v253, 65536, v249
    v_add_u32 v254, 65536, v250
    v_add_u32 v255, 65536, v251
    s_waitcnt lgkmcnt(14)
    v_mfma_f32_32x32x16_bf16 v[136:151], v[32:35], v[232:235], v[136:151]
    v_xor_b32 v7, 49152, v6
    ds_read_b128 v[40:43], v7
    ds_read_b64_tr_b16 v[216:217], v252 offset:0
    ds_read_b64_tr_b16 v[218:219], v252 offset:2048
    s_add_u32 m0, s47, 0
    s_movk_i32 s56, 384
    buffer_load_dwordx4 v2, s[4:7], s56 offen lds
    s_waitcnt lgkmcnt(15)
    v_mfma_f32_32x32x16_bf16 v[152:167], v[32:35], v[236:239], v[152:167]
    ds_read_b64_tr_b16 v[220:221], v253 offset:0
    ds_read_b64_tr_b16 v[222:223], v253 offset:2048
    ds_read_b64_tr_b16 v[224:225], v254 offset:0
    ds_read_b64_tr_b16 v[226:227], v254 offset:2048
    s_add_u32 m0, s47, 1024
    s_movk_i32 s56, 384
    buffer_load_dwordx4 v3, s[4:7], s56 offen lds
    s_waitcnt lgkmcnt(15)
    v_mfma_f32_32x32x16_bf16 v[168:183], v[32:35], v[240:243], v[168:183]
    ds_read_b64_tr_b16 v[228:229], v255 offset:0
    ds_read_b64_tr_b16 v[230:231], v255 offset:2048
    v_xor_b32 v7, 49184, v6
    ds_read_b128 v[44:47], v7
    v_mfma_f32_32x32x16_bf16 v[184:199], v[32:35], v[244:247], v[184:199]
    s_add_u32 m0, s47, 16384
    s_mov_b32 s56, 516096
    buffer_load_dwordx4 v4, s[8:11], s56 offen lds
    s_waitcnt lgkmcnt(15)
    v_mfma_f32_32x32x16_bf16 v[136:151], v[36:39], v[200:203], v[136:151]
    v_xor_b32 v7, 49216, v6
    ds_read_b128 v[48:51], v7
    v_xor_b32 v7, 49248, v6
    ds_read_b128 v[52:55], v7
    s_add_u32 m0, s47, 17408
    s_mov_b32 s56, 516096
    buffer_load_dwordx4 v5, s[8:11], s56 offen lds
    s_waitcnt lgkmcnt(15)
    v_mfma_f32_32x32x16_bf16 v[152:167], v[36:39], v[204:207], v[152:167]
    ds_read_b64_tr_b16 v[232:233], v252 offset:8192
    ds_read_b64_tr_b16 v[234:235], v252 offset:10240
    ds_read_b64_tr_b16 v[236:237], v253 offset:8192
    ds_read_b64_tr_b16 v[238:239], v253 offset:10240
    s_waitcnt lgkmcnt(15)
    v_mfma_f32_32x32x16_bf16 v[168:183], v[36:39], v[208:211], v[168:183]
    ds_read_b64_tr_b16 v[240:241], v254 offset:8192
    ds_read_b64_tr_b16 v[242:243], v254 offset:10240
    ds_read_b64_tr_b16 v[244:245], v255 offset:8192
    ds_read_b64_tr_b16 v[246:247], v255 offset:10240
    v_mfma_f32_32x32x16_bf16 v[184:199], v[36:39], v[212:215], v[184:199]
    s_waitcnt vmcnt(10)
    s_barrier
    v_add_u32 v252, 81920, v248
    v_add_u32 v253, 81920, v249
    v_add_u32 v254, 81920, v250
    v_add_u32 v255, 81920, v251
    s_waitcnt lgkmcnt(15)
    v_mfma_f32_32x32x16_bf16 v[136:151], v[40:43], v[216:219], v[136:151]
    ds_read_b64_tr_b16 v[200:201], v252 offset:0
    ds_read_b64_tr_b16 v[202:203], v252 offset:2048
    s_add_u32 m0, s47, 32768
    s_mov_b32 s56, 602112
    buffer_load_dwordx4 v4, s[8:11], s56 offen lds
    v_mfma_f32_32x32x16_bf16 v[152:167], v[40:43], v[220:223], v[152:167]
    ds_read_b64_tr_b16 v[204:205], v253 offset:0
    ds_read_b64_tr_b16 v[206:207], v253 offset:2048
    s_add_u32 m0, s47, 33792
    s_mov_b32 s56, 602112
    buffer_load_dwordx4 v5, s[8:11], s56 offen lds
    s_waitcnt lgkmcnt(15)
    v_mfma_f32_32x32x16_bf16 v[168:183], v[40:43], v[224:227], v[168:183]
    ds_read_b64_tr_b16 v[208:209], v254 offset:0
    ds_read_b64_tr_b16 v[210:211], v254 offset:2048
    v_mfma_f32_32x32x16_bf16 v[184:199], v[40:43], v[228:231], v[184:199]
    ds_read_b64_tr_b16 v[212:213], v255 offset:0
    ds_read_b64_tr_b16 v[214:215], v255 offset:2048
    s_waitcnt lgkmcnt(14)
    v_mfma_f32_32x32x16_bf16 v[136:151], v[44:47], v[232:235], v[136:151]
    ds_read_b64_tr_b16 v[216:217], v252 offset:8192
    ds_read_b64_tr_b16 v[218:219], v252 offset:10240
    s_waitcnt lgkmcnt(14)
    v_mfma_f32_32x32x16_bf16 v[152:167], v[44:47], v[236:239], v[152:167]
    ds_read_b64_tr_b16 v[220:221], v253 offset:8192
    ds_read_b64_tr_b16 v[222:223], v253 offset:10240
    s_waitcnt lgkmcnt(14)
    v_mfma_f32_32x32x16_bf16 v[168:183], v[44:47], v[240:243], v[168:183]
    ds_read_b64_tr_b16 v[224:225], v254 offset:8192
    ds_read_b64_tr_b16 v[226:227], v254 offset:10240
    s_waitcnt lgkmcnt(14)
    v_mfma_f32_32x32x16_bf16 v[184:199], v[44:47], v[244:247], v[184:199]
    ds_read_b64_tr_b16 v[228:229], v255 offset:8192
    ds_read_b64_tr_b16 v[230:231], v255 offset:10240
    s_waitcnt vmcnt(8)
    s_barrier
    v_add_u32 v252, 114688, v248
    v_add_u32 v253, 114688, v249
    v_add_u32 v254, 114688, v250
    v_add_u32 v255, 114688, v251
    s_waitcnt lgkmcnt(14)
    v_mfma_f32_32x32x16_bf16 v[136:151], v[48:51], v[200:203], v[136:151]
    v_xor_b32 v7, 98304, v6
    ds_read_b128 v[56:59], v7
    ds_read_b64_tr_b16 v[232:233], v252 offset:0
    ds_read_b64_tr_b16 v[234:235], v252 offset:2048
    s_add_u32 m0, s47, 49152
    s_movk_i32 s56, 512
    buffer_load_dwordx4 v2, s[4:7], s56 offen lds
    s_waitcnt lgkmcnt(15)
    v_mfma_f32_32x32x16_bf16 v[152:167], v[48:51], v[204:207], v[152:167]
    ds_read_b64_tr_b16 v[236:237], v253 offset:0
    ds_read_b64_tr_b16 v[238:239], v253 offset:2048
    ds_read_b64_tr_b16 v[240:241], v254 offset:0
    ds_read_b64_tr_b16 v[242:243], v254 offset:2048
    s_add_u32 m0, s47, 50176
    s_movk_i32 s56, 512
    buffer_load_dwordx4 v3, s[4:7], s56 offen lds
    s_waitcnt lgkmcnt(15)
    v_mfma_f32_32x32x16_bf16 v[168:183], v[48:51], v[208:211], v[168:183]
    ds_read_b64_tr_b16 v[244:245], v255 offset:0
    ds_read_b64_tr_b16 v[246:247], v255 offset:2048
    v_xor_b32 v7, 98336, v6
    ds_read_b128 v[60:63], v7
    v_mfma_f32_32x32x16_bf16 v[184:199], v[48:51], v[212:215], v[184:199]
    s_add_u32 m0, s47, 65536
    s_mov_b32 s56, 688128
    buffer_load_dwordx4 v4, s[8:11], s56 offen lds
    s_waitcnt lgkmcnt(15)
    v_mfma_f32_32x32x16_bf16 v[136:151], v[52:55], v[216:219], v[136:151]
    v_xor_b32 v7, 98368, v6
    ds_read_b128 v[64:67], v7
    v_xor_b32 v7, 98400, v6
    ds_read_b128 v[68:71], v7
    s_add_u32 m0, s47, 66560
    s_mov_b32 s56, 688128
    buffer_load_dwordx4 v5, s[8:11], s56 offen lds
    s_waitcnt lgkmcnt(15)
    v_mfma_f32_32x32x16_bf16 v[152:167], v[52:55], v[220:223], v[152:167]
    ds_read_b64_tr_b16 v[200:201], v252 offset:8192
    ds_read_b64_tr_b16 v[202:203], v252 offset:10240
    ds_read_b64_tr_b16 v[204:205], v253 offset:8192
    ds_read_b64_tr_b16 v[206:207], v253 offset:10240
    s_waitcnt lgkmcnt(15)
    v_mfma_f32_32x32x16_bf16 v[168:183], v[52:55], v[224:227], v[168:183]
    ds_read_b64_tr_b16 v[208:209], v254 offset:8192
    ds_read_b64_tr_b16 v[210:211], v254 offset:10240
    ds_read_b64_tr_b16 v[212:213], v255 offset:8192
    ds_read_b64_tr_b16 v[214:215], v255 offset:10240
    v_mfma_f32_32x32x16_bf16 v[184:199], v[52:55], v[228:231], v[184:199]
    s_waitcnt vmcnt(10)
    s_barrier
    v_add_u32 v252, 131072, v248
    v_add_u32 v253, 131072, v249
    v_add_u32 v254, 131072, v250
    v_add_u32 v255, 131072, v251
    s_waitcnt lgkmcnt(15)
    v_mfma_f32_32x32x16_bf16 v[136:151], v[56:59], v[232:235], v[136:151]
    ds_read_b64_tr_b16 v[216:217], v252 offset:0
    ds_read_b64_tr_b16 v[218:219], v252 offset:2048
    s_add_u32 m0, s47, 81920
    s_mov_b32 s56, 774144
    buffer_load_dwordx4 v4, s[8:11], s56 offen lds
    v_mfma_f32_32x32x16_bf16 v[152:167], v[56:59], v[236:239], v[152:167]
    ds_read_b64_tr_b16 v[220:221], v253 offset:0
    ds_read_b64_tr_b16 v[222:223], v253 offset:2048
    s_add_u32 m0, s47, 82944
    s_mov_b32 s56, 774144
    buffer_load_dwordx4 v5, s[8:11], s56 offen lds
    s_waitcnt lgkmcnt(15)
    v_mfma_f32_32x32x16_bf16 v[168:183], v[56:59], v[240:243], v[168:183]
    ds_read_b64_tr_b16 v[224:225], v254 offset:0
    ds_read_b64_tr_b16 v[226:227], v254 offset:2048
    v_mfma_f32_32x32x16_bf16 v[184:199], v[56:59], v[244:247], v[184:199]
    ds_read_b64_tr_b16 v[228:229], v255 offset:0
    ds_read_b64_tr_b16 v[230:231], v255 offset:2048
    s_waitcnt lgkmcnt(14)
    v_mfma_f32_32x32x16_bf16 v[136:151], v[60:63], v[200:203], v[136:151]
    ds_read_b64_tr_b16 v[232:233], v252 offset:8192
    ds_read_b64_tr_b16 v[234:235], v252 offset:10240
    s_waitcnt lgkmcnt(14)
    v_mfma_f32_32x32x16_bf16 v[152:167], v[60:63], v[204:207], v[152:167]
    ds_read_b64_tr_b16 v[236:237], v253 offset:8192
    ds_read_b64_tr_b16 v[238:239], v253 offset:10240
    s_waitcnt lgkmcnt(14)
    v_mfma_f32_32x32x16_bf16 v[168:183], v[60:63], v[208:211], v[168:183]
    ds_read_b64_tr_b16 v[240:241], v254 offset:8192
    ds_read_b64_tr_b16 v[242:243], v254 offset:10240
    s_waitcnt lgkmcnt(14)
    v_mfma_f32_32x32x16_bf16 v[184:199], v[60:63], v[212:215], v[184:199]
    ds_read_b64_tr_b16 v[244:245], v255 offset:8192
    ds_read_b64_tr_b16 v[246:247], v255 offset:10240
    s_waitcnt vmcnt(8)
    s_barrier
    v_add_u32 v252, 16384, v248
    v_add_u32 v253, 16384, v249
    v_add_u32 v254, 16384, v250
    v_add_u32 v255, 16384, v251
    v_mov_b32 v20, 0
    buffer_load_dwordx2 v[18:19], v20, s[32:35], 0 offen sc1
    s_waitcnt lgkmcnt(14)
    v_mfma_f32_32x32x16_bf16 v[136:151], v[64:67], v[216:219], v[136:151]
    v_xor_b32 v7, 0, v6
    ds_read_b128 v[72:75], v7
    ds_read_b64_tr_b16 v[200:201], v252 offset:0
    ds_read_b64_tr_b16 v[202:203], v252 offset:2048
    s_add_u32 m0, s47, 98304
    s_movk_i32 s56, 640
    buffer_load_dwordx4 v2, s[4:7], s56 offen lds
    s_waitcnt lgkmcnt(15)
    v_mfma_f32_32x32x16_bf16 v[152:167], v[64:67], v[220:223], v[152:167]
    ds_read_b64_tr_b16 v[204:205], v253 offset:0
    ds_read_b64_tr_b16 v[206:207], v253 offset:2048
    ds_read_b64_tr_b16 v[208:209], v254 offset:0
    ds_read_b64_tr_b16 v[210:211], v254 offset:2048
    s_add_u32 m0, s47, 99328
    s_movk_i32 s56, 640
    buffer_load_dwordx4 v3, s[4:7], s56 offen lds
    s_waitcnt lgkmcnt(15)
    v_mfma_f32_32x32x16_bf16 v[168:183], v[64:67], v[224:227], v[168:183]
    ds_read_b64_tr_b16 v[212:213], v255 offset:0
    ds_read_b64_tr_b16 v[214:215], v255 offset:2048
    v_xor_b32 v7, 32, v6
    ds_read_b128 v[76:79], v7
    v_mfma_f32_32x32x16_bf16 v[184:199], v[64:67], v[228:231], v[184:199]
    s_add_u32 m0, s47, 114688
    s_mov_b32 s56, 860160
    buffer_load_dwordx4 v4, s[8:11], s56 offen lds
    s_waitcnt lgkmcnt(15)
    v_mfma_f32_32x32x16_bf16 v[136:151], v[68:71], v[232:235], v[136:151]
    v_xor_b32 v7, 64, v6
    ds_read_b128 v[80:83], v7
    v_xor_b32 v7, 96, v6
    ds_read_b128 v[84:87], v7
    s_add_u32 m0, s47, 115712
    s_mov_b32 s56, 860160
    buffer_load_dwordx4 v5, s[8:11], s56 offen lds
    s_waitcnt lgkmcnt(15)
    v_mfma_f32_32x32x16_bf16 v[152:167], v[68:71], v[236:239], v[152:167]
    ds_read_b64_tr_b16 v[216:217], v252 offset:8192
    ds_read_b64_tr_b16 v[218:219], v252 offset:10240
    ds_read_b64_tr_b16 v[220:221], v253 offset:8192
    ds_read_b64_tr_b16 v[222:223], v253 offset:10240
    s_waitcnt lgkmcnt(15)
    v_mfma_f32_32x32x16_bf16 v[168:183], v[68:71], v[240:243], v[168:183]
    ds_read_b64_tr_b16 v[224:225], v254 offset:8192
    ds_read_b64_tr_b16 v[226:227], v254 offset:10240
    ds_read_b64_tr_b16 v[228:229], v255 offset:8192
    ds_read_b64_tr_b16 v[230:231], v255 offset:10240
    v_mfma_f32_32x32x16_bf16 v[184:199], v[68:71], v[244:247], v[184:199]
    s_waitcnt vmcnt(11)
    s_barrier
    v_add_u32 v252, 32768, v248
    v_add_u32 v253, 32768, v249
    v_add_u32 v254, 32768, v250
    v_add_u32 v255, 32768, v251
    s_waitcnt lgkmcnt(15)
    v_mfma_f32_32x32x16_bf16 v[136:151], v[72:75], v[200:203], v[136:151]
    ds_read_b64_tr_b16 v[232:233], v252 offset:0
    ds_read_b64_tr_b16 v[234:235], v252 offset:2048
    s_add_u32 m0, s47, 131072
    s_mov_b32 s56, 946176
    buffer_load_dwordx4 v4, s[8:11], s56 offen lds
    v_mfma_f32_32x32x16_bf16 v[152:167], v[72:75], v[204:207], v[152:167]
    ds_read_b64_tr_b16 v[236:237], v253 offset:0
    ds_read_b64_tr_b16 v[238:239], v253 offset:2048
    s_add_u32 m0, s47, 132096
    s_mov_b32 s56, 946176
    buffer_load_dwordx4 v5, s[8:11], s56 offen lds
    s_waitcnt lgkmcnt(15)
    v_mfma_f32_32x32x16_bf16 v[168:183], v[72:75], v[208:211], v[168:183]
    ds_read_b64_tr_b16 v[240:241], v254 offset:0
    ds_read_b64_tr_b16 v[242:243], v254 offset:2048
    v_mfma_f32_32x32x16_bf16 v[184:199], v[72:75], v[212:215], v[184:199]
    ds_read_b64_tr_b16 v[244:245], v255 offset:0
    ds_read_b64_tr_b16 v[246:247], v255 offset:2048
    s_waitcnt lgkmcnt(14)
    v_mfma_f32_32x32x16_bf16 v[136:151], v[76:79], v[216:219], v[136:151]
    ds_read_b64_tr_b16 v[200:201], v252 offset:8192
    ds_read_b64_tr_b16 v[202:203], v252 offset:10240
    s_waitcnt lgkmcnt(14)
    v_mfma_f32_32x32x16_bf16 v[152:167], v[76:79], v[220:223], v[152:167]
    ds_read_b64_tr_b16 v[204:205], v253 offset:8192
    ds_read_b64_tr_b16 v[206:207], v253 offset:10240
    s_waitcnt lgkmcnt(14)
    v_mfma_f32_32x32x16_bf16 v[168:183], v[76:79], v[224:227], v[168:183]
    ds_read_b64_tr_b16 v[208:209], v254 offset:8192
    ds_read_b64_tr_b16 v[210:211], v254 offset:10240
    s_waitcnt lgkmcnt(14)
    v_mfma_f32_32x32x16_bf16 v[184:199], v[76:79], v[228:231], v[184:199]
    ds_read_b64_tr_b16 v[212:213], v255 offset:8192
    ds_read_b64_tr_b16 v[214:215], v255 offset:10240
    s_waitcnt vmcnt(9)
    s_barrier
    v_add_u32 v252, 65536, v248
    v_add_u32 v253, 65536, v249
    v_add_u32 v254, 65536, v250
    v_add_u32 v255, 65536, v251
    s_waitcnt lgkmcnt(14)
    v_mfma_f32_32x32x16_bf16 v[136:151], v[80:83], v[232:235], v[136:151]
    v_xor_b32 v7, 49152, v6
    ds_read_b128 v[88:91], v7
    ds_read_b64_tr_b16 v[216:217], v252 offset:0
    ds_read_b64_tr_b16 v[218:219], v252 offset:2048
    s_add_u32 m0, s47, 0
    s_movk_i32 s56, 768
    buffer_load_dwordx4 v2, s[4:7], s56 offen lds
    s_waitcnt lgkmcnt(15)
    v_mfma_f32_32x32x16_bf16 v[152:167], v[80:83], v[236:239], v[152:167]
    ds_read_b64_tr_b16 v[220:221], v253 offset:0
    ds_read_b64_tr_b16 v[222:223], v253 offset:2048
    ds_read_b64_tr_b16 v[224:225], v254 offset:0
    ds_read_b64_tr_b16 v[226:227], v254 offset:2048
    s_add_u32 m0, s47, 1024
    s_movk_i32 s56, 768
    buffer_load_dwordx4 v3, s[4:7], s56 offen lds
    s_waitcnt lgkmcnt(15)
    v_mfma_f32_32x32x16_bf16 v[168:183], v[80:83], v[240:243], v[168:183]
    ds_read_b64_tr_b16 v[228:229], v255 offset:0
    ds_read_b64_tr_b16 v[230:231], v255 offset:2048
    v_xor_b32 v7, 49184, v6
    ds_read_b128 v[92:95], v7
    v_mfma_f32_32x32x16_bf16 v[184:199], v[80:83], v[244:247], v[184:199]
    s_add_u32 m0, s47, 16384
    s_mov_b32 s56, 1032192
    buffer_load_dwordx4 v4, s[8:11], s56 offen lds
    s_waitcnt lgkmcnt(15)
    v_mfma_f32_32x32x16_bf16 v[136:151], v[84:87], v[200:203], v[136:151]
    v_xor_b32 v7, 49216, v6
    ds_read_b128 v[96:99], v7
    v_xor_b32 v7, 49248, v6
    ds_read_b128 v[100:103], v7
    s_add_u32 m0, s47, 17408
    s_mov_b32 s56, 1032192
    buffer_load_dwordx4 v5, s[8:11], s56 offen lds
    s_waitcnt lgkmcnt(15)
    v_mfma_f32_32x32x16_bf16 v[152:167], v[84:87], v[204:207], v[152:167]
    ds_read_b64_tr_b16 v[232:233], v252 offset:8192
    ds_read_b64_tr_b16 v[234:235], v252 offset:10240
    ds_read_b64_tr_b16 v[236:237], v253 offset:8192
    ds_read_b64_tr_b16 v[238:239], v253 offset:10240
    s_waitcnt lgkmcnt(15)
    v_mfma_f32_32x32x16_bf16 v[168:183], v[84:87], v[208:211], v[168:183]
    ds_read_b64_tr_b16 v[240:241], v254 offset:8192
    ds_read_b64_tr_b16 v[242:243], v254 offset:10240
    ds_read_b64_tr_b16 v[244:245], v255 offset:8192
    ds_read_b64_tr_b16 v[246:247], v255 offset:10240
    v_mfma_f32_32x32x16_bf16 v[184:199], v[84:87], v[212:215], v[184:199]
    s_waitcnt vmcnt(11)
    s_barrier
    v_add_u32 v252, 81920, v248
    v_add_u32 v253, 81920, v249
    v_add_u32 v254, 81920, v250
    v_add_u32 v255, 81920, v251
    s_waitcnt lgkmcnt(15)
    v_mfma_f32_32x32x16_bf16 v[136:151], v[88:91], v[216:219], v[136:151]
    ds_read_b64_tr_b16 v[200:201], v252 offset:0
    ds_read_b64_tr_b16 v[202:203], v252 offset:2048
    s_add_u32 m0, s47, 32768
    s_mov_b32 s56, 1118208
    buffer_load_dwordx4 v4, s[8:11], s56 offen lds
    v_mfma_f32_32x32x16_bf16 v[152:167], v[88:91], v[220:223], v[152:167]
    ds_read_b64_tr_b16 v[204:205], v253 offset:0
    ds_read_b64_tr_b16 v[206:207], v253 offset:2048
    s_add_u32 m0, s47, 33792
    s_mov_b32 s56, 1118208
    buffer_load_dwordx4 v5, s[8:11], s56 offen lds
    s_waitcnt lgkmcnt(15)
    v_mfma_f32_32x32x16_bf16 v[168:183], v[88:91], v[224:227], v[168:183]
    ds_read_b64_tr_b16 v[208:209], v254 offset:0
    ds_read_b64_tr_b16 v[210:211], v254 offset:2048
    v_mfma_f32_32x32x16_bf16 v[184:199], v[88:91], v[228:231], v[184:199]
    ds_read_b64_tr_b16 v[212:213], v255 offset:0
    ds_read_b64_tr_b16 v[214:215], v255 offset:2048
    s_waitcnt lgkmcnt(14)
    v_mfma_f32_32x32x16_bf16 v[136:151], v[92:95], v[232:235], v[136:151]
    ds_read_b64_tr_b16 v[216:217], v252 offset:8192
    ds_read_b64_tr_b16 v[218:219], v252 offset:10240
    s_waitcnt lgkmcnt(14)
    v_mfma_f32_32x32x16_bf16 v[152:167], v[92:95], v[236:239], v[152:167]
    ds_read_b64_tr_b16 v[220:221], v253 offset:8192
    ds_read_b64_tr_b16 v[222:223], v253 offset:10240
    s_waitcnt lgkmcnt(14)
    v_mfma_f32_32x32x16_bf16 v[168:183], v[92:95], v[240:243], v[168:183]
    ds_read_b64_tr_b16 v[224:225], v254 offset:8192
    ds_read_b64_tr_b16 v[226:227], v254 offset:10240
    s_waitcnt lgkmcnt(14)
    v_mfma_f32_32x32x16_bf16 v[184:199], v[92:95], v[244:247], v[184:199]
    ds_read_b64_tr_b16 v[228:229], v255 offset:8192
    ds_read_b64_tr_b16 v[230:231], v255 offset:10240
    s_waitcnt vmcnt(8)
    s_barrier
    v_add_u32 v252, 114688, v248
    v_add_u32 v253, 114688, v249
    v_add_u32 v254, 114688, v250
    v_add_u32 v255, 114688, v251
    s_waitcnt vmcnt(12)
    v_readfirstlane_b32 s60, v18
    v_readfirstlane_b32 s61, v19
    s_nop 0
    s_cmp_lg_u32 s61, 0
    s_cbranch_scc1 L_tagok_74
    s_mov_b32 s58, 0x4000
    v_mov_b32 v20, 0
L_tag_75:
    buffer_load_dwordx2 v[18:19], v20, s[32:35], 0 offen sc1
    s_waitcnt vmcnt(0)
    v_readfirstlane_b32 s60, v18
    v_readfirstlane_b32 s61, v19
    s_nop 0
    s_cmp_lg_u32 s61, 0
    s_cbranch_scc1 L_tagd_76
    s_sleep 4
    s_sub_u32 s58, s58, 1
    s_cmp_lg_u32 s58, 0
    s_cbranch_scc1 L_tag_75
L_tagd_76:
L_tagok_74:
    v_mov_b32 v12, s60
    v_mov_b32 v13, s61
    v_lshlrev_b32 v14, 3, v1
    s_waitcnt lgkmcnt(14)
    v_mfma_f32_32x32x16_bf16 v[136:151], v[96:99], v[200:203], v[136:151]
    v_xor_b32 v7, 98304, v6
    ds_read_b128 v[104:107], v7
    ds_read_b64_tr_b16 v[232:233], v252 offset:0
    ds_read_b64_tr_b16 v[234:235], v252 offset:2048
    s_waitcnt lgkmcnt(15)
    v_mfma_f32_32x32x16_bf16 v[152:167], v[96:99], v[204:207], v[152:167]
    ds_read_b64_tr_b16 v[236:237], v253 offset:0
    ds_read_b64_tr_b16 v[238:239], v253 offset:2048
    ds_read_b64_tr_b16 v[240:241], v254 offset:0
    ds_read_b64_tr_b16 v[242:243], v254 offset:2048
    s_waitcnt lgkmcnt(15)
    v_mfma_f32_32x32x16_bf16 v[168:183], v[96:99], v[208:211], v[168:183]
    ds_read_b64_tr_b16 v[244:245], v255 offset:0
    ds_read_b64_tr_b16 v[246:247], v255 offset:2048
    v_xor_b32 v7, 98336, v6
    ds_read_b128 v[108:111], v7
    v_mfma_f32_32x32x16_bf16 v[184:199], v[96:99], v[212:215], v[184:199]
    s_waitcnt lgkmcnt(15)
    v_mfma_f32_32x32x16_bf16 v[136:151], v[100:103], v[216:219], v[136:151]
    v_xor_b32 v7, 98368, v6
    ds_read_b128 v[112:115], v7
    v_xor_b32 v7, 98400, v6
    ds_read_b128 v[116:119], v7
    s_waitcnt lgkmcnt(15)
    v_mfma_f32_32x32x16_bf16 v[152:167], v[100:103], v[220:223], v[152:167]
    ds_read_b64_tr_b16 v[200:201], v252 offset:8192
    ds_read_b64_tr_b16 v[202:203], v252 offset:10240
    ds_read_b64_tr_b16 v[204:205], v253 offset:8192
    ds_read_b64_tr_b16 v[206:207], v253 offset:10240
    s_waitcnt lgkmcnt(15)
    v_mfma_f32_32x32x16_bf16 v[168:183], v[100:103], v[224:227], v[168:183]
    ds_read_b64_tr_b16 v[208:209], v254 offset:8192
    ds_read_b64_tr_b16 v[210:211], v254 offset:10240
    ds_read_b64_tr_b16 v[212:213], v255 offset:8192
    ds_read_b64_tr_b16 v[214:215], v255 offset:10240
    v_mfma_f32_32x32x16_bf16 v[184:199], v[100:103], v[228:231], v[184:199]
    s_waitcnt vmcnt(6)
    s_barrier
    v_add_u32 v252, 131072, v248
    v_add_u32 v253, 131072, v249
    v_add_u32 v254, 131072, v250
    v_add_u32 v255, 131072, v251
    s_waitcnt lgkmcnt(15)
    v_mfma_f32_32x32x16_bf16 v[136:151], v[104:107], v[232:235], v[136:151]
    ds_read_b64_tr_b16 v[216:217], v252 offset:0
    ds_read_b64_tr_b16 v[218:219], v252 offset:2048
    v_mfma_f32_32x32x16_bf16 v[152:167], v[104:107], v[236:239], v[152:167]
    ds_read_b64_tr_b16 v[220:221], v253 offset:0
    ds_read_b64_tr_b16 v[222:223], v253 offset:2048
    s_waitcnt lgkmcnt(15)
    v_mfma_f32_32x32x16_bf16 v[168:183], v[104:107], v[240:243], v[168:183]
    ds_read_b64_tr_b16 v[224:225], v254 offset:0
    ds_read_b64_tr_b16 v[226:227], v254 offset:2048
    v_mfma_f32_32x32x16_bf16 v[184:199], v[104:107], v[244:247], v[184:199]
    ds_read_b64_tr_b16 v[228:229], v255 offset:0
    ds_read_b64_tr_b16 v[230:231], v255 offset:2048
    s_waitcnt lgkmcnt(14)
    v_mfma_f32_32x32x16_bf16 v[136:151], v[108:111], v[200:203], v[136:151]
    ds_read_b64_tr_b16 v[232:233], v252 offset:8192
    ds_read_b64_tr_b16 v[234:235], v252 offset:10240
    s_waitcnt lgkmcnt(14)
    v_mfma_f32_32x32x16_bf16 v[152:167], v[108:111], v[204:207], v[152:167]
    ds_read_b64_tr_b16 v[236:237], v253 offset:8192
    ds_read_b64_tr_b16 v[238:239], v253 offset:10240
    s_waitcnt lgkmcnt(14)
    v_mfma_f32_32x32x16_bf16 v[168:183], v[108:111], v[208:211], v[168:183]
    ds_read_b64_tr_b16 v[240:241], v254 offset:8192
    ds_read_b64_tr_b16 v[242:243], v254 offset:10240
    s_waitcnt lgkmcnt(14)
    v_mfma_f32_32x32x16_bf16 v[184:199], v[108:111], v[212:215], v[184:199]
    ds_read_b64_tr_b16 v[244:245], v255 offset:8192
    ds_read_b64_tr_b16 v[246:247], v255 offset:10240
    s_waitcnt vmcnt(2)
    s_barrier
    v_add_u32 v252, 16384, v248
    v_add_u32 v253, 16384, v249
    v_add_u32 v254, 16384, v250
    v_add_u32 v255, 16384, v251
    s_waitcnt lgkmcnt(14)
    v_mfma_f32_32x32x16_bf16 v[136:151], v[112:115], v[216:219], v[136:151]
    v_xor_b32 v7, 0, v6
    ds_read_b128 v[120:123], v7
    ds_read_b64_tr_b16 v[200:201], v252 offset:0
    ds_read_b64_tr_b16 v[202:203], v252 offset:2048
    s_waitcnt lgkmcnt(15)
    v_mfma_f32_32x32x16_bf16 v[152:167], v[112:115], v[220:223], v[152:167]
    ds_read_b64_tr_b16 v[204:205], v253 offset:0
    ds_read_b64_tr_b16 v[206:207], v253 offset:2048
    ds_read_b64_tr_b16 v[208:209], v254 offset:0
    ds_read_b64_tr_b16 v[210:211], v254 offset:2048
    s_waitcnt lgkmcnt(15)
    v_mfma_f32_32x32x16_bf16 v[168:183], v[112:115], v[224:227], v[168:183]
    ds_read_b64_tr_b16 v[212:213], v255 offset:0
    ds_read_b64_tr_b16 v[214:215], v255 offset:2048
    v_xor_b32 v7, 32, v6
    ds_read_b128 v[124:127], v7
    v_mfma_f32_32x32x16_bf16 v[184:199], v[112:115], v[228:231], v[184:199]
    s_waitcnt lgkmcnt(15)
    v_mfma_f32_32x32x16_bf16 v[136:151], v[116:119], v[232:235], v[136:151]
    v_xor_b32 v7, 64, v6
    ds_read_b128 v[128:131], v7
    v_xor_b32 v7, 96, v6
    ds_read_b128 v[132:135], v7
    s_waitcnt lgkmcnt(15)
    v_mfma_f32_32x32x16_bf16 v[152:167], v[116:119], v[236:239], v[152:167]
    ds_read_b64_tr_b16 v[216:217], v252 offset:8192
    ds_read_b64_tr_b16 v[218:219], v252 offset:10240
    ds_read_b64_tr_b16 v[220:221], v253 offset:8192
    ds_read_b64_tr_b16 v[222:223], v253 offset:10240
    s_waitcnt lgkmcnt(15)
    v_mfma_f32_32x32x16_bf16 v[168:183], v[116:119], v[240:243], v[168:183]
    ds_read_b64_tr_b16 v[224:225], v254 offset:8192
    ds_read_b64_tr_b16 v[226:227], v254 offset:10240
    ds_read_b64_tr_b16 v[228:229], v255 offset:8192
    ds_read_b64_tr_b16 v[230:231], v255 offset:10240
    v_mfma_f32_32x32x16_bf16 v[184:199], v[116:119], v[244:247], v[184:199]
    s_waitcnt vmcnt(0)
    s_barrier
    v_add_u32 v252, 32768, v248
    v_add_u32 v253, 32768, v249
    v_add_u32 v254, 32768, v250
    v_add_u32 v255, 32768, v251
    s_waitcnt lgkmcnt(15)
    v_mfma_f32_32x32x16_bf16 v[136:151], v[120:123], v[200:203], v[136:151]
    ds_read_b64_tr_b16 v[232:233], v252 offset:0
    ds_read_b64_tr_b16 v[234:235], v252 offset:2048
    v_mfma_f32_32x32x16_bf16 v[152:167], v[120:123], v[204:207], v[152:167]
    ds_read_b64_tr_b16 v[236:237], v253 offset:0
    ds_read_b64_tr_b16 v[238:239], v253 offset:2048
    s_waitcnt lgkmcnt(15)
    v_mfma_f32_32x32x16_bf16 v[168:183], v[120:123], v[208:211], v[168:183]
    ds_read_b64_tr_b16 v[240:241], v254 offset:0
    ds_read_b64_tr_b16 v[242:243], v254 offset:2048
    v_mfma_f32_32x32x16_bf16 v[184:199], v[120:123], v[212:215], v[184:199]
    ds_read_b64_tr_b16 v[244:245], v255 offset:0
    ds_read_b64_tr_b16 v[246:247], v255 offset:2048
    s_waitcnt lgkmcnt(14)
    v_mfma_f32_32x32x16_bf16 v[136:151], v[124:127], v[216:219], v[136:151]
    ds_read_b64_tr_b16 v[200:201], v252 offset:8192
    ds_read_b64_tr_b16 v[202:203], v252 offset:10240
    s_waitcnt lgkmcnt(14)
    v_mfma_f32_32x32x16_bf16 v[152:167], v[124:127], v[220:223], v[152:167]
    ds_read_b64_tr_b16 v[204:205], v253 offset:8192
    ds_read_b64_tr_b16 v[206:207], v253 offset:10240
    s_waitcnt lgkmcnt(14)
    v_mfma_f32_32x32x16_bf16 v[168:183], v[124:127], v[224:227], v[168:183]
    ds_read_b64_tr_b16 v[208:209], v254 offset:8192
    ds_read_b64_tr_b16 v[210:211], v254 offset:10240
    s_waitcnt lgkmcnt(14)
    v_mfma_f32_32x32x16_bf16 v[184:199], v[124:127], v[228:231], v[184:199]
    ds_read_b64_tr_b16 v[212:213], v255 offset:8192
    ds_read_b64_tr_b16 v[214:215], v255 offset:10240
    s_waitcnt vmcnt(0) lgkmcnt(0)
    s_barrier
    v_mfma_f32_32x32x16_bf16 v[136:151], v[128:131], v[232:235], v[136:151]
    v_mfma_f32_32x32x16_bf16 v[152:167], v[128:131], v[236:239], v[152:167]
    v_mfma_f32_32x32x16_bf16 v[168:183], v[128:131], v[240:243], v[168:183]
    v_mfma_f32_32x32x16_bf16 v[184:199], v[128:131], v[244:247], v[184:199]
    v_mfma_f32_32x32x16_bf16 v[136:151], v[132:135], v[200:203], v[136:151]
    v_mfma_f32_32x32x16_bf16 v[152:167], v[132:135], v[204:207], v[152:167]
    v_mfma_f32_32x32x16_bf16 v[168:183], v[132:135], v[208:211], v[168:183]
    v_mfma_f32_32x32x16_bf16 v[184:199], v[132:135], v[212:215], v[184:199]
    s_mul_i32 s53, s45, 28672
    s_lshl_b32 s54, s43, 9
    s_add_u32 s53, s53, s54
    s_add_u32 s53, s53, 4194304
    s_add_u32 s54, s53, 14336
    s_nop 3
    v_cvt_pk_bf16_f32 v136, v136, v137
    v_cvt_pk_bf16_f32 v137, v138, v139
    v_cvt_pk_bf16_f32 v138, v140, v141
    v_cvt_pk_bf16_f32 v139, v142, v143
    v_cvt_pk_bf16_f32 v140, v144, v145
    v_cvt_pk_bf16_f32 v141, v146, v147
    v_cvt_pk_bf16_f32 v142, v148, v149
    v_cvt_pk_bf16_f32 v143, v150, v151
    buffer_store_dwordx4 v[136:139], v15, s[24:27], s53 offen offset:0 sc1
    buffer_store_dwordx4 v[140:143], v15, s[24:27], s54 offen offset:0 sc1
    v_cvt_pk_bf16_f32 v152, v152, v153
    v_cvt_pk_bf16_f32 v153, v154, v155
    v_cvt_pk_bf16_f32 v154, v156, v157
    v_cvt_pk_bf16_f32 v155, v158, v159
    v_cvt_pk_bf16_f32 v156, v160, v161
    v_cvt_pk_bf16_f32 v157, v162, v163
    v_cvt_pk_bf16_f32 v158, v164, v165
    v_cvt_pk_bf16_f32 v159, v166, v167
    buffer_store_dwordx4 v[152:155], v15, s[24:27], s53 offen offset:512 sc1
    buffer_store_dwordx4 v[156:159], v15, s[24:27], s54 offen offset:512 sc1
    v_cvt_pk_bf16_f32 v168, v168, v169
    v_cvt_pk_bf16_f32 v169, v170, v171
    v_cvt_pk_bf16_f32 v170, v172, v173
    v_cvt_pk_bf16_f32 v171, v174, v175
    v_cvt_pk_bf16_f32 v172, v176, v177
    v_cvt_pk_bf16_f32 v173, v178, v179
    v_cvt_pk_bf16_f32 v174, v180, v181
    v_cvt_pk_bf16_f32 v175, v182, v183
    buffer_store_dwordx4 v[168:171], v15, s[24:27], s53 offen offset:1024 sc1
    buffer_store_dwordx4 v[172:175], v15, s[24:27], s54 offen offset:1024 sc1
    v_cvt_pk_bf16_f32 v184, v184, v185
    v_cvt_pk_bf16_f32 v185, v186, v187
    v_cvt_pk_bf16_f32 v186, v188, v189
    v_cvt_pk_bf16_f32 v187, v190, v191
    v_cvt_pk_bf16_f32 v188, v192, v193
    v_cvt_pk_bf16_f32 v189, v194, v195
    v_cvt_pk_bf16_f32 v190, v196, v197
    v_cvt_pk_bf16_f32 v191, v198, v199
    buffer_store_dwordx4 v[184:187], v15, s[24:27], s53 offen offset:1536 sc1
    buffer_store_dwordx4 v[188:191], v15, s[24:27], s54 offen offset:1536 sc1
    s_waitcnt vmcnt(0)
    s_barrier
    s_add_u32 s57, s55, 14
    s_lshl_b32 s53, s42, 4
    s_add_u32 s53, s53, s57
    s_lshl_b32 s53, s53, 7
    s_lshl_b32 s54, s3, 24
    s_add_u32 s53, s53, s54
    s_add_u32 s53, s53, 15794176
    s_mov_b64 exec, 0xffff
    buffer_store_dwordx2 v[12:13], v14, s[24:27], s53 offen sc1
    s_mov_b64 exec, -1
    s_mul_i32 s71, s62, 7
    s_lshr_b32 s71, s71, 1
    s_lshr_b32 s50, s71, 3
    s_add_u32 s51, s71, 3
    s_lshr_b32 s51, s51, 3
    s_lshl_b32 s51, s51, 8
    s_or_b32 s56, s50, s51
    s_lshr_b32 s50, s62, 3
    s_mul_i32 s50, s50, 0x01010000
    s_or_b32 s98, s50, s56
    s_add_u32 s98, s98, 0x0e0e0707
    s_mul_i32 s56, s56, 0x10001
    v_bfe_u32 v2, v1, 2, 2
    v_lshlrev_b32 v2, 3, v2
    v_lshrrev_b32 v3, v2, s98
    v_lshrrev_b32 v2, v2, s56
    v_and_b32 v4, 3, v1
    s_lshl_b32 s50, s3, 2
    v_add_u32 v4, s50, v4
    v_mov_b32 v5, s63
    v_cmp_le_u32 vcc, 32, v1
    s_nop 1
    v_cndmask_b32 v2, v3, v2, vcc
    v_cndmask_b32 v4, v4, v5, vcc
    v_and_b32 v2, 0xff, v2
    v_lshl_add_u32 v2, v4, 4, v2
    v_lshlrev_b32 v2, 7, v2
    v_add_u32 v2, 15794176, v2
    s_lshl_b32 s50, s63, 2
    s_add_u32 s99, s50, s3
    v_and_b32 v5, 31, v1
    v_cmp_eq_u32 vcc, 28, v5
    v_mov_b32 v4, 0x3f803f80
    s_nop 0
    v_cndmask_b32 v4, 0, v4, vcc
    v_lshlrev_b32 v5, 2, v5
    s_mov_b32 s66, 0x0fffffff
    s_mov_b32 s67, 0x0fffffff
    s_lshl_b32 s51, s71, 9
    s_mul_i32 s68, s3, 917504
    s_add_u32 s68, s68, s51
    s_add_u32 s68, s68, 28672
    s_mul_i32 s69, s62, 448
    s_mul_i32 s52, s3, 458752
    s_add_u32 s69, s69, s52
    s_add_u32 s69, s69, 4194304
    v_lshrrev_b32 v3, 5, v1
    v_mul_u32_u24 v3, 6656, v3
    v_add_u32 v3, v3, v16
    v_add_u32 v23, 14336, v3
    s_mul_i32 s47, s63, 229376
    s_add_u32 s47, s47, s51
    s_lshl_b32 s50, s99, 4
    s_add_u32 s50, s50, s62
    s_lshl_b32 s46, s50, 11
    s_add_u32 s46, s46, 13631488
    s_add_u32 s50, s3, 1
    s_and_b32 s50, s50, 3
    s_mul_i32 s50, s50, 12288
    s_add_u32 s50, s50, 49152
    v_add_u32 v6, s50, v16
    s_add_u32 s50, s3, 2
    s_and_b32 s50, s50, 3
    s_mul_i32 s50, s50, 12288
    s_add_u32 s50, s50, 53248
    v_add_u32 v7, s50, v16
    s_add_u32 s50, s3, 3
    s_and_b32 s50, s50, 3
    s_mul_i32 s50, s50, 12288
    s_add_u32 s50, s50, 57344
    v_add_u32 v8, s50, v16
    s_add_u32 s50, s3, 4
    s_and_b32 s50, s50, 3
    s_mul_i32 s50, s50, 12288
    s_add_u32 s50, s50, 49152
    v_add_u32 v15, s50, v16
    v_mov_b32 v24, -1
    v_mov_b32 v25, -1
    v_mov_b32 v26, -1
    v_mov_b32 v27, -1
    buffer_store_dwordx4 v[24:27], v16, s[24:27], s46 offen offset:0 sc1
    buffer_store_dwordx4 v[24:27], v16, s[24:27], s46 offen offset:1024 sc1
    s_nop 1
    v_mov_b32 v24, v4
    v_mov_b32 v25, v4
    v_mov_b32 v26, v4
    v_mov_b32 v27, v4
    v_mov_b32 v28, v4
    v_mov_b32 v29, v4
    v_mov_b32 v30, v4
    v_mov_b32 v31, v4
    v_mov_b32 v32, v4
    v_mov_b32 v33, v4
    v_mov_b32 v34, v4
    v_mov_b32 v35, v4
    v_mov_b32 v36, v4
    v_mov_b32 v37, v4
    v_mov_b32 v38, v4
    v_mov_b32 v39, v4
    v_mov_b32 v40, v4
    v_mov_b32 v41, v4
    v_mov_b32 v42, v4
    v_mov_b32 v43, v4
    v_mov_b32 v44, v4
    v_mov_b32 v45, v4
    v_mov_b32 v46, v4
    v_mov_b32 v47, v4
    v_mov_b32 v48, v4
    v_mov_b32 v49, v4
    v_mov_b32 v50, v4
    v_mov_b32 v51, v4
    v_mov_b32 v52, v4
    v_mov_b32 v53, v4
    v_mov_b32 v54, v4
    v_mov_b32 v55, v4
    s_mov_b32 s59, 16777216
    s_mov_b32 s64, 0
    s_branch L_attn_late
L_v_hi:
    v_lshrrev_b32 v15, 5, v1
    v_mul_u32_u24 v15, 6656, v15
    v_add_u32 v15, v15, v16
    s_waitcnt vmcnt(7)
    s_barrier
    v_add_u32 v252, 16384, v248
    v_add_u32 v253, 16384, v249
    v_add_u32 v254, 16384, v250
    v_xor_b32 v7, 0, v6
    ds_read_b128 v[24:27], v7
    ds_read_b64_tr_b16 v[200:201], v252 offset:0
    ds_read_b64_tr_b16 v[202:203], v252 offset:2048
    ds_read_b64_tr_b16 v[204:205], v253 offset:0
    ds_read_b64_tr_b16 v[206:207], v253 offset:2048
    ds_read_b64_tr_b16 v[208:209], v254 offset:0
    ds_read_b64_tr_b16 v[210:211], v254 offset:2048
    v_xor_b32 v7, 32, v6
    ds_read_b128 v[28:31], v7
    s_add_u32 m0, s47, 81920
    s_mov_b32 s56, 258048
    buffer_load_dwordx4 v4, s[8:11], s56 offen lds
    s_add_u32 m0, s47, 82944
    s_mov_b32 s56, 258048
    buffer_load_dwordx4 v5, s[8:11], s56 offen lds
    v_xor_b32 v7, 64, v6
    ds_read_b128 v[32:35], v7
    v_xor_b32 v7, 96, v6
    ds_read_b128 v[36:39], v7
    ds_read_b64_tr_b16 v[216:217], v252 offset:8192
    ds_read_b64_tr_b16 v[218:219], v252 offset:10240
    ds_read_b64_tr_b16 v[220:221], v253 offset:8192
    ds_read_b64_tr_b16 v[222:223], v253 offset:10240
    ds_read_b64_tr_b16 v[224:225], v254 offset:8192
    ds_read_b64_tr_b16 v[226:227], v254 offset:10240
    s_add_u32 m0, s47, 98304
    s_movk_i32 s56, 256
    buffer_load_dwordx4 v2, s[4:7], s56 offen lds
    s_add_u32 m0, s47, 99328
    s_movk_i32 s56, 256
    buffer_load_dwordx4 v3, s[4:7], s56 offen lds
    s_waitcnt vmcnt(9)
    s_barrier
    v_add_u32 v252, 32768, v248
    v_add_u32 v253, 32768, v249
    v_add_u32 v254, 32768, v250
    s_cmp_lg_u32 s3, 0
    s_cbranch_scc1 L_cinit_77
    v_lshlrev_b32 v18, 2, v1
    v_add_u32 v18, 155648, v18
    v_cmp_eq_u32 vcc, 1, v1
    s_nop 1
    v_cndmask_b32 v19, 0, 8, vcc
    ds_write_b32 v18, v19
L_cinit_77:
    s_waitcnt lgkmcnt(13)
    v_mfma_f32_32x32x16_bf16 v[136:151], v[24:27], v[200:203], 0
    ds_read_b64_tr_b16 v[232:233], v252 offset:0
    ds_read_b64_tr_b16 v[234:235], v252 offset:2048
    s_add_u32 m0, s47, 114688
    s_mov_b32 s56, 344064
    buffer_load_dwordx4 v4, s[8:11], s56 offen lds
    s_waitcnt lgkmcnt(13)
    v_mfma_f32_32x32x16_bf16 v[152:167], v[24:27], v[204:207], 0
    ds_read_b64_tr_b16 v[236:237], v253 offset:0
    ds_read_b64_tr_b16 v[238:239], v253 offset:2048
    s_add_u32 m0, s47, 115712
    s_mov_b32 s56, 344064
    buffer_load_dwordx4 v5, s[8:11], s56 offen lds
    s_waitcnt lgkmcnt(13)
    v_mfma_f32_32x32x16_bf16 v[168:183], v[24:27], v[208:211], 0
    ds_read_b64_tr_b16 v[240:241], v254 offset:0
    ds_read_b64_tr_b16 v[242:243], v254 offset:2048
    s_add_u32 m0, s47, 131072
    s_mov_b32 s56, 430080
    buffer_load_dwordx4 v4, s[8:11], s56 offen lds
    s_waitcnt lgkmcnt(10)
    v_mfma_f32_32x32x16_bf16 v[136:151], v[28:31], v[216:219], v[136:151]
    ds_read_b64_tr_b16 v[200:201], v252 offset:8192
    ds_read_b64_tr_b16 v[202:203], v252 offset:10240
    s_add_u32 m0, s47, 132096
    s_mov_b32 s56, 430080
    buffer_load_dwordx4 v5, s[8:11], s56 offen lds
    s_waitcnt lgkmcnt(10)
    v_mfma_f32_32x32x16_bf16 v[152:167], v[28:31], v[220:223], v[152:167]
    ds_read_b64_tr_b16 v[204:205], v253 offset:8192
    ds_read_b64_tr_b16 v[206:207], v253 offset:10240
    s_waitcnt lgkmcnt(10)
    v_mfma_f32_32x32x16_bf16 v[168:183], v[28:31], v[224:227], v[168:183]
    ds_read_b64_tr_b16 v[208:209], v254 offset:8192
    ds_read_b64_tr_b16 v[210:211], v254 offset:10240
    s_waitcnt vmcnt(9)
    s_barrier
    v_add_u32 v252, 65536, v248
    v_add_u32 v253, 65536, v249
    v_add_u32 v254, 65536, v250
    s_waitcnt lgkmcnt(10)
    v_mfma_f32_32x32x16_bf16 v[136:151], v[32:35], v[232:235], v[136:151]
    v_xor_b32 v7, 49152, v6
    ds_read_b128 v[40:43], v7
    ds_read_b64_tr_b16 v[216:217], v252 offset:0
    ds_read_b64_tr_b16 v[218:219], v252 offset:2048
    s_add_u32 m0, s47, 0
    s_movk_i32 s56, 384
    buffer_load_dwordx4 v2, s[4:7], s56 offen lds
    s_waitcnt lgkmcnt(11)
    v_mfma_f32_32x32x16_bf16 v[152:167], v[32:35], v[236:239], v[152:167]
    ds_read_b64_tr_b16 v[220:221], v253 offset:0
    ds_read_b64_tr_b16 v[222:223], v253 offset:2048
    ds_read_b64_tr_b16 v[224:225], v254 offset:0
    ds_read_b64_tr_b16 v[226:227], v254 offset:2048
    s_add_u32 m0, s47, 1024
    s_movk_i32 s56, 384
    buffer_load_dwordx4 v3, s[4:7], s56 offen lds
    s_waitcnt lgkmcnt(13)
    v_mfma_f32_32x32x16_bf16 v[168:183], v[32:35], v[240:243], v[168:183]
    v_xor_b32 v7, 49184, v6
    ds_read_b128 v[44:47], v7
    s_add_u32 m0, s47, 16384
    s_mov_b32 s56, 516096
    buffer_load_dwordx4 v4, s[8:11], s56 offen lds
    s_waitcnt lgkmcnt(12)
    v_mfma_f32_32x32x16_bf16 v[136:151], v[36:39], v[200:203], v[136:151]
    v_xor_b32 v7, 49216, v6
    ds_read_b128 v[48:51], v7
    v_xor_b32 v7, 49248, v6
    ds_read_b128 v[52:55], v7
    s_add_u32 m0, s47, 17408
    s_mov_b32 s56, 516096
    buffer_load_dwordx4 v5, s[8:11], s56 offen lds
    s_waitcnt lgkmcnt(12)
    v_mfma_f32_32x32x16_bf16 v[152:167], v[36:39], v[204:207], v[152:167]
    ds_read_b64_tr_b16 v[232:233], v252 offset:8192
    ds_read_b64_tr_b16 v[234:235], v252 offset:10240
    ds_read_b64_tr_b16 v[236:237], v253 offset:8192
    ds_read_b64_tr_b16 v[238:239], v253 offset:10240
    s_waitcnt lgkmcnt(14)
    v_mfma_f32_32x32x16_bf16 v[168:183], v[36:39], v[208:211], v[168:183]
    ds_read_b64_tr_b16 v[240:241], v254 offset:8192
    ds_read_b64_tr_b16 v[242:243], v254 offset:10240
    s_waitcnt vmcnt(10)
    s_barrier
    v_add_u32 v252, 81920, v248
    v_add_u32 v253, 81920, v249
    v_add_u32 v254, 81920, v250
    s_waitcnt lgkmcnt(13)
    v_mfma_f32_32x32x16_bf16 v[136:151], v[40:43], v[216:219], v[136:151]
    ds_read_b64_tr_b16 v[200:201], v252 offset:0
    ds_read_b64_tr_b16 v[202:203], v252 offset:2048
    s_add_u32 m0, s47, 32768
    s_mov_b32 s56, 602112
    buffer_load_dwordx4 v4, s[8:11], s56 offen lds
    s_waitcnt lgkmcnt(13)
    v_mfma_f32_32x32x16_bf16 v[152:167], v[40:43], v[220:223], v[152:167]
    ds_read_b64_tr_b16 v[204:205], v253 offset:0
    ds_read_b64_tr_b16 v[206:207], v253 offset:2048
    s_add_u32 m0, s47, 33792
    s_mov_b32 s56, 602112
    buffer_load_dwordx4 v5, s[8:11], s56 offen lds
    s_waitcnt lgkmcnt(13)
    v_mfma_f32_32x32x16_bf16 v[168:183], v[40:43], v[224:227], v[168:183]
    ds_read_b64_tr_b16 v[208:209], v254 offset:0
    ds_read_b64_tr_b16 v[210:211], v254 offset:2048
    s_waitcnt lgkmcnt(10)
    v_mfma_f32_32x32x16_bf16 v[136:151], v[44:47], v[232:235], v[136:151]
    ds_read_b64_tr_b16 v[216:217], v252 offset:8192
    ds_read_b64_tr_b16 v[218:219], v252 offset:10240
    s_waitcnt lgkmcnt(10)
    v_mfma_f32_32x32x16_bf16 v[152:167], v[44:47], v[236:239], v[152:167]
    ds_read_b64_tr_b16 v[220:221], v253 offset:8192
    ds_read_b64_tr_b16 v[222:223], v253 offset:10240
    s_waitcnt lgkmcnt(10)
    v_mfma_f32_32x32x16_bf16 v[168:183], v[44:47], v[240:243], v[168:183]
    ds_read_b64_tr_b16 v[224:225], v254 offset:8192
    ds_read_b64_tr_b16 v[226:227], v254 offset:10240
    s_waitcnt vmcnt(8)
    s_barrier
    v_add_u32 v252, 114688, v248
    v_add_u32 v253, 114688, v249
    v_add_u32 v254, 114688, v250
    s_waitcnt lgkmcnt(10)
    v_mfma_f32_32x32x16_bf16 v[136:151], v[48:51], v[200:203], v[136:151]
    v_xor_b32 v7, 98304, v6
    ds_read_b128 v[56:59], v7
    ds_read_b64_tr_b16 v[232:233], v252 offset:0
    ds_read_b64_tr_b16 v[234:235], v252 offset:2048
    s_add_u32 m0, s47, 49152
    s_movk_i32 s56, 512
    buffer_load_dwordx4 v2, s[4:7], s56 offen lds
    s_waitcnt lgkmcnt(11)
    v_mfma_f32_32x32x16_bf16 v[152:167], v[48:51], v[204:207], v[152:167]
    ds_read_b64_tr_b16 v[236:237], v253 offset:0
    ds_read_b64_tr_b16 v[238:239], v253 offset:2048
    ds_read_b64_tr_b16 v[240:241], v254 offset:0
    ds_read_b64_tr_b16 v[242:243], v254 offset:2048
    s_add_u32 m0, s47, 50176
    s_movk_i32 s56, 512
    buffer_load_dwordx4 v3, s[4:7], s56 offen lds
    s_waitcnt lgkmcnt(13)
    v_mfma_f32_32x32x16_bf16 v[168:183], v[48:51], v[208:211], v[168:183]
    v_xor_b32 v7, 98336, v6
    ds_read_b128 v[60:63], v7
    s_add_u32 m0, s47, 65536
    s_mov_b32 s56, 688128
    buffer_load_dwordx4 v4, s[8:11], s56 offen lds
    s_waitcnt lgkmcnt(12)
    v_mfma_f32_32x32x16_bf16 v[136:151], v[52:55], v[216:219], v[136:151]
    v_xor_b32 v7, 98368, v6
    ds_read_b128 v[64:67], v7
    v_xor_b32 v7, 98400, v6
    ds_read_b128 v[68:71], v7
    s_add_u32 m0, s47, 66560
    s_mov_b32 s56, 688128
    buffer_load_dwordx4 v5, s[8:11], s56 offen lds
    s_waitcnt lgkmcnt(12)
    v_mfma_f32_32x32x16_bf16 v[152:167], v[52:55], v[220:223], v[152:167]
    ds_read_b64_tr_b16 v[200:201], v252 offset:8192
    ds_read_b64_tr_b16 v[202:203], v252 offset:10240
    ds_read_b64_tr_b16 v[204:205], v253 offset:8192
    ds_read_b64_tr_b16 v[206:207], v253 offset:10240
    s_waitcnt lgkmcnt(14)
    v_mfma_f32_32x32x16_bf16 v[168:183], v[52:55], v[224:227], v[168:183]
    ds_read_b64_tr_b16 v[208:209], v254 offset:8192
    ds_read_b64_tr_b16 v[210:211], v254 offset:10240
    s_waitcnt vmcnt(10)
    s_barrier
    v_add_u32 v252, 131072, v248
    v_add_u32 v253, 131072, v249
    v_add_u32 v254, 131072, v250
    s_waitcnt lgkmcnt(13)
    v_mfma_f32_32x32x16_bf16 v[136:151], v[56:59], v[232:235], v[136:151]
    ds_read_b64_tr_b16 v[216:217], v252 offset:0
    ds_read_b64_tr_b16 v[218:219], v252 offset:2048
    s_add_u32 m0, s47, 81920
    s_mov_b32 s56, 774144
    buffer_load_dwordx4 v4, s[8:11], s56 offen lds
    s_waitcnt lgkmcnt(13)
    v_mfma_f32_32x32x16_bf16 v[152:167], v[56:59], v[236:239], v[152:167]
    ds_read_b64_tr_b16 v[220:221], v253 offset:0
    ds_read_b64_tr_b16 v[222:223], v253 offset:2048
    s_add_u32 m0, s47, 82944
    s_mov_b32 s56, 774144
    buffer_load_dwordx4 v5, s[8:11], s56 offen lds
    s_waitcnt lgkmcnt(13)
    v_mfma_f32_32x32x16_bf16 v[168:183], v[56:59], v[240:243], v[168:183]
    ds_read_b64_tr_b16 v[224:225], v254 offset:0
    ds_read_b64_tr_b16 v[226:227], v254 offset:2048
    s_waitcnt lgkmcnt(10)
    v_mfma_f32_32x32x16_bf16 v[136:151], v[60:63], v[200:203], v[136:151]
    ds_read_b64_tr_b16 v[232:233], v252 offset:8192
    ds_read_b64_tr_b16 v[234:235], v252 offset:10240
    s_waitcnt lgkmcnt(10)
    v_mfma_f32_32x32x16_bf16 v[152:167], v[60:63], v[204:207], v[152:167]
    ds_read_b64_tr_b16 v[236:237], v253 offset:8192
    ds_read_b64_tr_b16 v[238:239], v253 offset:10240
    s_waitcnt lgkmcnt(10)
    v_mfma_f32_32x32x16_bf16 v[168:183], v[60:63], v[208:211], v[168:183]
    ds_read_b64_tr_b16 v[240:241], v254 offset:8192
    ds_read_b64_tr_b16 v[242:243], v254 offset:10240
    s_waitcnt vmcnt(8)
    s_barrier
    v_add_u32 v252, 16384, v248
    v_add_u32 v253, 16384, v249
    v_add_u32 v254, 16384, v250
    v_mov_b32 v20, 0
    buffer_load_dwordx2 v[18:19], v20, s[32:35], 0 offen sc1
    s_waitcnt lgkmcnt(10)
    v_mfma_f32_32x32x16_bf16 v[136:151], v[64:67], v[216:219], v[136:151]
    v_xor_b32 v7, 0, v6
    ds_read_b128 v[72:75], v7
    ds_read_b64_tr_b16 v[200:201], v252 offset:0
    ds_read_b64_tr_b16 v[202:203], v252 offset:2048
    s_add_u32 m0, s47, 98304
    s_movk_i32 s56, 640
    buffer_load_dwordx4 v2, s[4:7], s56 offen lds
    s_waitcnt lgkmcnt(11)
    v_mfma_f32_32x32x16_bf16 v[152:167], v[64:67], v[220:223], v[152:167]
    ds_read_b64_tr_b16 v[204:205], v253 offset:0
    ds_read_b64_tr_b16 v[206:207], v253 offset:2048
    ds_read_b64_tr_b16 v[208:209], v254 offset:0
    ds_read_b64_tr_b16 v[210:211], v254 offset:2048
    s_add_u32 m0, s47, 99328
    s_movk_i32 s56, 640
    buffer_load_dwordx4 v3, s[4:7], s56 offen lds
    s_waitcnt lgkmcnt(13)
    v_mfma_f32_32x32x16_bf16 v[168:183], v[64:67], v[224:227], v[168:183]
    v_xor_b32 v7, 32, v6
    ds_read_b128 v[76:79], v7
    s_add_u32 m0, s47, 114688
    s_mov_b32 s56, 860160
    buffer_load_dwordx4 v4, s[8:11], s56 offen lds
    s_waitcnt lgkmcnt(12)
    v_mfma_f32_32x32x16_bf16 v[136:151], v[68:71], v[232:235], v[136:151]
    v_xor_b32 v7, 64, v6
    ds_read_b128 v[80:83], v7
    v_xor_b32 v7, 96, v6
    ds_read_b128 v[84:87], v7
    s_add_u32 m0, s47, 115712
    s_mov_b32 s56, 860160
    buffer_load_dwordx4 v5, s[8:11], s56 offen lds
    s_waitcnt lgkmcnt(12)
    v_mfma_f32_32x32x16_bf16 v[152:167], v[68:71], v[236:239], v[152:167]
    ds_read_b64_tr_b16 v[216:217], v252 offset:8192
    ds_read_b64_tr_b16 v[218:219], v252 offset:10240
    ds_read_b64_tr_b16 v[220:221], v253 offset:8192
    ds_read_b64_tr_b16 v[222:223], v253 offset:10240
    s_waitcnt lgkmcnt(14)
    v_mfma_f32_32x32x16_bf16 v[168:183], v[68:71], v[240:243], v[168:183]
    ds_read_b64_tr_b16 v[224:225], v254 offset:8192
    ds_read_b64_tr_b16 v[226:227], v254 offset:10240
    s_waitcnt vmcnt(11)
    s_barrier
    v_add_u32 v252, 32768, v248
    v_add_u32 v253, 32768, v249
    v_add_u32 v254, 32768, v250
    s_waitcnt lgkmcnt(13)
    v_mfma_f32_32x32x16_bf16 v[136:151], v[72:75], v[200:203], v[136:151]
    ds_read_b64_tr_b16 v[232:233], v252 offset:0
    ds_read_b64_tr_b16 v[234:235], v252 offset:2048
    s_add_u32 m0, s47, 131072
    s_mov_b32 s56, 946176
    buffer_load_dwordx4 v4, s[8:11], s56 offen lds
    s_waitcnt lgkmcnt(13)
    v_mfma_f32_32x32x16_bf16 v[152:167], v[72:75], v[204:207], v[152:167]
    ds_read_b64_tr_b16 v[236:237], v253 offset:0
    ds_read_b64_tr_b16 v[238:239], v253 offset:2048
    s_add_u32 m0, s47, 132096
    s_mov_b32 s56, 946176
    buffer_load_dwordx4 v5, s[8:11], s56 offen lds
    s_waitcnt lgkmcnt(13)
    v_mfma_f32_32x32x16_bf16 v[168:183], v[72:75], v[208:211], v[168:183]
    ds_read_b64_tr_b16 v[240:241], v254 offset:0
    ds_read_b64_tr_b16 v[242:243], v254 offset:2048
    s_waitcnt lgkmcnt(10)
    v_mfma_f32_32x32x16_bf16 v[136:151], v[76:79], v[216:219], v[136:151]
    ds_read_b64_tr_b16 v[200:201], v252 offset:8192
    ds_read_b64_tr_b16 v[202:203], v252 offset:10240
    s_waitcnt lgkmcnt(10)
    v_mfma_f32_32x32x16_bf16 v[152:167], v[76:79], v[220:223], v[152:167]
    ds_read_b64_tr_b16 v[204:205], v253 offset:8192
    ds_read_b64_tr_b16 v[206:207], v253 offset:10240
    s_waitcnt lgkmcnt(10)
    v_mfma_f32_32x32x16_bf16 v[168:183], v[76:79], v[224:227], v[168:183]
    ds_read_b64_tr_b16 v[208:209], v254 offset:8192
    ds_read_b64_tr_b16 v[210:211], v254 offset:10240
    s_waitcnt vmcnt(9)
    s_barrier
    v_add_u32 v252, 65536, v248
    v_add_u32 v253, 65536, v249
    v_add_u32 v254, 65536, v250
    s_waitcnt lgkmcnt(10)
    v_mfma_f32_32x32x16_bf16 v[136:151], v[80:83], v[232:235], v[136:151]
    v_xor_b32 v7, 49152, v6
    ds_read_b128 v[88:91], v7
    ds_read_b64_tr_b16 v[216:217], v252 offset:0
    ds_read_b64_tr_b16 v[218:219], v252 offset:2048
    s_add_u32 m0, s47, 0
    s_movk_i32 s56, 768
    buffer_load_dwordx4 v2, s[4:7], s56 offen lds
    s_waitcnt lgkmcnt(11)
    v_mfma_f32_32x32x16_bf16 v[152:167], v[80:83], v[236:239], v[152:167]
    ds_read_b64_tr_b16 v[220:221], v253 offset:0
    ds_read_b64_tr_b16 v[222:223], v253 offset:2048
    ds_read_b64_tr_b16 v[224:225], v254 offset:0
    ds_read_b64_tr_b16 v[226:227], v254 offset:2048
    s_add_u32 m0, s47, 1024
    s_movk_i32 s56, 768
    buffer_load_dwordx4 v3, s[4:7], s56 offen lds
    s_waitcnt lgkmcnt(13)
    v_mfma_f32_32x32x16_bf16 v[168:183], v[80:83], v[240:243], v[168:183]
    v_xor_b32 v7, 49184, v6
    ds_read_b128 v[92:95], v7
    s_add_u32 m0, s47, 16384
    s_mov_b32 s56, 1032192
    buffer_load_dwordx4 v4, s[8:11], s56 offen lds
    s_waitcnt lgkmcnt(12)
    v_mfma_f32_32x32x16_bf16 v[136:151], v[84:87], v[200:203], v[136:151]
    v_xor_b32 v7, 49216, v6
    ds_read_b128 v[96:99], v7
    v_xor_b32 v7, 49248, v6
    ds_read_b128 v[100:103], v7
    s_add_u32 m0, s47, 17408
    s_mov_b32 s56, 1032192
    buffer_load_dwordx4 v5, s[8:11], s56 offen lds
    s_waitcnt lgkmcnt(12)
    v_mfma_f32_32x32x16_bf16 v[152:167], v[84:87], v[204:207], v[152:167]
    ds_read_b64_tr_b16 v[232:233], v252 offset:8192
    ds_read_b64_tr_b16 v[234:235], v252 offset:10240
    ds_read_b64_tr_b16 v[236:237], v253 offset:8192
    ds_read_b64_tr_b16 v[238:239], v253 offset:10240
    s_waitcnt lgkmcnt(14)
    v_mfma_f32_32x32x16_bf16 v[168:183], v[84:87], v[208:211], v[168:183]
    ds_read_b64_tr_b16 v[240:241], v254 offset:8192
    ds_read_b64_tr_b16 v[242:243], v254 offset:10240
    s_waitcnt vmcnt(11)
    s_barrier
    v_add_u32 v252, 81920, v248
    v_add_u32 v253, 81920, v249
    v_add_u32 v254, 81920, v250
    s_waitcnt lgkmcnt(13)
    v_mfma_f32_32x32x16_bf16 v[136:151], v[88:91], v[216:219], v[136:151]
    ds_read_b64_tr_b16 v[200:201], v252 offset:0
    ds_read_b64_tr_b16 v[202:203], v252 offset:2048
    s_add_u32 m0, s47, 32768
    s_mov_b32 s56, 1118208
    buffer_load_dwordx4 v4, s[8:11], s56 offen lds
    s_waitcnt lgkmcnt(13)
    v_mfma_f32_32x32x16_bf16 v[152:167], v[88:91], v[220:223], v[152:167]
    ds_read_b64_tr_b16 v[204:205], v253 offset:0
    ds_read_b64_tr_b16 v[206:207], v253 offset:2048
    s_add_u32 m0, s47, 33792
    s_mov_b32 s56, 1118208
    buffer_load_dwordx4 v5, s[8:11], s56 offen lds
    s_waitcnt lgkmcnt(13)
    v_mfma_f32_32x32x16_bf16 v[168:183], v[88:91], v[224:227], v[168:183]
    ds_read_b64_tr_b16 v[208:209], v254 offset:0
    ds_read_b64_tr_b16 v[210:211], v254 offset:2048
    s_waitcnt lgkmcnt(10)
    v_mfma_f32_32x32x16_bf16 v[136:151], v[92:95], v[232:235], v[136:151]
    ds_read_b64_tr_b16 v[216:217], v252 offset:8192
    ds_read_b64_tr_b16 v[218:219], v252 offset:10240
    s_waitcnt lgkmcnt(10)
    v_mfma_f32_32x32x16_bf16 v[152:167], v[92:95], v[236:239], v[152:167]
    ds_read_b64_tr_b16 v[220:221], v253 offset:8192
    ds_read_b64_tr_b16 v[222:223], v253 offset:10240
    s_waitcnt lgkmcnt(10)
    v_mfma_f32_32x32x16_bf16 v[168:183], v[92:95], v[240:243], v[168:183]
    ds_read_b64_tr_b16 v[224:225], v254 offset:8192
    ds_read_b64_tr_b16 v[226:227], v254 offset:10240
    s_waitcnt vmcnt(8)
    s_barrier
    v_add_u32 v252, 114688, v248
    v_add_u32 v253, 114688, v249
    v_add_u32 v254, 114688, v250
    s_waitcnt vmcnt(12)
    v_readfirstlane_b32 s60, v18
    v_readfirstlane_b32 s61, v19
    s_nop 0
    s_cmp_lg_u32 s61, 0
    s_cbranch_scc1 L_tagok_78
    s_mov_b32 s58, 0x4000
    v_mov_b32 v20, 0
L_tag_79:
    buffer_load_dwordx2 v[18:19], v20, s[32:35], 0 offen sc1
    s_waitcnt vmcnt(0)
    v_readfirstlane_b32 s60, v18
    v_readfirstlane_b32 s61, v19
    s_nop 0
    s_cmp_lg_u32 s61, 0
    s_cbranch_scc1 L_tagd_80
    s_sleep 4
    s_sub_u32 s58, s58, 1
    s_cmp_lg_u32 s58, 0
    s_cbranch_scc1 L_tag_79
L_tagd_80:
L_tagok_78:
    v_mov_b32 v12, s60
    v_mov_b32 v13, s61
    v_lshlrev_b32 v14, 3, v1
    s_waitcnt lgkmcnt(10)
    v_mfma_f32_32x32x16_bf16 v[136:151], v[96:99], v[200:203], v[136:151]
    v_xor_b32 v7, 98304, v6
    ds_read_b128 v[104:107], v7
    ds_read_b64_tr_b16 v[232:233], v252 offset:0
    ds_read_b64_tr_b16 v[234:235], v252 offset:2048
    s_waitcnt lgkmcnt(11)
    v_mfma_f32_32x32x16_bf16 v[152:167], v[96:99], v[204:207], v[152:167]
    ds_read_b64_tr_b16 v[236:237], v253 offset:0
    ds_read_b64_tr_b16 v[238:239], v253 offset:2048
    ds_read_b64_tr_b16 v[240:241], v254 offset:0
    ds_read_b64_tr_b16 v[242:243], v254 offset:2048
    s_waitcnt lgkmcnt(13)
    v_mfma_f32_32x32x16_bf16 v[168:183], v[96:99], v[208:211], v[168:183]
    v_xor_b32 v7, 98336, v6
    ds_read_b128 v[108:111], v7
    s_waitcnt lgkmcnt(12)
    v_mfma_f32_32x32x16_bf16 v[136:151], v[100:103], v[216:219], v[136:151]
    v_xor_b32 v7, 98368, v6
    ds_read_b128 v[112:115], v7
    v_xor_b32 v7, 98400, v6
    ds_read_b128 v[116:119], v7
    s_waitcnt lgkmcnt(12)
    v_mfma_f32_32x32x16_bf16 v[152:167], v[100:103], v[220:223], v[152:167]
    ds_read_b64_tr_b16 v[200:201], v252 offset:8192
    ds_read_b64_tr_b16 v[202:203], v252 offset:10240
    ds_read_b64_tr_b16 v[204:205], v253 offset:8192
    ds_read_b64_tr_b16 v[206:207], v253 offset:10240
    s_waitcnt lgkmcnt(14)
    v_mfma_f32_32x32x16_bf16 v[168:183], v[100:103], v[224:227], v[168:183]
    ds_read_b64_tr_b16 v[208:209], v254 offset:8192
    ds_read_b64_tr_b16 v[210:211], v254 offset:10240
    s_waitcnt vmcnt(6)
    s_barrier
    v_add_u32 v252, 131072, v248
    v_add_u32 v253, 131072, v249
    v_add_u32 v254, 131072, v250
    s_waitcnt lgkmcnt(13)
    v_mfma_f32_32x32x16_bf16 v[136:151], v[104:107], v[232:235], v[136:151]
    ds_read_b64_tr_b16 v[216:217], v252 offset:0
    ds_read_b64_tr_b16 v[218:219], v252 offset:2048
    s_waitcnt lgkmcnt(13)
    v_mfma_f32_32x32x16_bf16 v[152:167], v[104:107], v[236:239], v[152:167]
    ds_read_b64_tr_b16 v[220:221], v253 offset:0
    ds_read_b64_tr_b16 v[222:223], v253 offset:2048
    s_waitcnt lgkmcnt(13)
    v_mfma_f32_32x32x16_bf16 v[168:183], v[104:107], v[240:243], v[168:183]
    ds_read_b64_tr_b16 v[224:225], v254 offset:0
    ds_read_b64_tr_b16 v[226:227], v254 offset:2048
    s_waitcnt lgkmcnt(10)
    v_mfma_f32_32x32x16_bf16 v[136:151], v[108:111], v[200:203], v[136:151]
    ds_read_b64_tr_b16 v[232:233], v252 offset:8192
    ds_read_b64_tr_b16 v[234:235], v252 offset:10240
    s_waitcnt lgkmcnt(10)
    v_mfma_f32_32x32x16_bf16 v[152:167], v[108:111], v[204:207], v[152:167]
    ds_read_b64_tr_b16 v[236:237], v253 offset:8192
    ds_read_b64_tr_b16 v[238:239], v253 offset:10240
    s_waitcnt lgkmcnt(10)
    v_mfma_f32_32x32x16_bf16 v[168:183], v[108:111], v[208:211], v[168:183]
    ds_read_b64_tr_b16 v[240:241], v254 offset:8192
    ds_read_b64_tr_b16 v[242:243], v254 offset:10240
    s_waitcnt vmcnt(2)
    s_barrier
    v_add_u32 v252, 16384, v248
    v_add_u32 v253, 16384, v249
    v_add_u32 v254, 16384, v250
    s_waitcnt lgkmcnt(10)
    v_mfma_f32_32x32x16_bf16 v[136:151], v[112:115], v[216:219], v[136:151]
    v_xor_b32 v7, 0, v6
    ds_read_b128 v[120:123], v7
    ds_read_b64_tr_b16 v[200:201], v252 offset:0
    ds_read_b64_tr_b16 v[202:203], v252 offset:2048
    s_waitcnt lgkmcnt(11)
    v_mfma_f32_32x32x16_bf16 v[152:167], v[112:115], v[220:223], v[152:167]
    ds_read_b64_tr_b16 v[204:205], v253 offset:0
    ds_read_b64_tr_b16 v[206:207], v253 offset:2048
    ds_read_b64_tr_b16 v[208:209], v254 offset:0
    ds_read_b64_tr_b16 v[210:211], v254 offset:2048
    s_waitcnt lgkmcnt(13)
    v_mfma_f32_32x32x16_bf16 v[168:183], v[112:115], v[224:227], v[168:183]
    v_xor_b32 v7, 32, v6
    ds_read_b128 v[124:127], v7
    s_waitcnt lgkmcnt(12)
    v_mfma_f32_32x32x16_bf16 v[136:151], v[116:119], v[232:235], v[136:151]
    v_xor_b32 v7, 64, v6
    ds_read_b128 v[128:131], v7
    v_xor_b32 v7, 96, v6
    ds_read_b128 v[132:135], v7
    s_waitcnt lgkmcnt(12)
    v_mfma_f32_32x32x16_bf16 v[152:167], v[116:119], v[236:239], v[152:167]
    ds_read_b64_tr_b16 v[216:217], v252 offset:8192
    ds_read_b64_tr_b16 v[218:219], v252 offset:10240
    ds_read_b64_tr_b16 v[220:221], v253 offset:8192
    ds_read_b64_tr_b16 v[222:223], v253 offset:10240
    s_waitcnt lgkmcnt(14)
    v_mfma_f32_32x32x16_bf16 v[168:183], v[116:119], v[240:243], v[168:183]
    ds_read_b64_tr_b16 v[224:225], v254 offset:8192
    ds_read_b64_tr_b16 v[226:227], v254 offset:10240
    s_waitcnt vmcnt(0)
    s_barrier
    v_add_u32 v252, 32768, v248
    v_add_u32 v253, 32768, v249
    v_add_u32 v254, 32768, v250
    s_waitcnt lgkmcnt(13)
    v_mfma_f32_32x32x16_bf16 v[136:151], v[120:123], v[200:203], v[136:151]
    ds_read_b64_tr_b16 v[232:233], v252 offset:0
    ds_read_b64_tr_b16 v[234:235], v252 offset:2048
    s_waitcnt lgkmcnt(13)
    v_mfma_f32_32x32x16_bf16 v[152:167], v[120:123], v[204:207], v[152:167]
    ds_read_b64_tr_b16 v[236:237], v253 offset:0
    ds_read_b64_tr_b16 v[238:239], v253 offset:2048
    s_waitcnt lgkmcnt(13)
    v_mfma_f32_32x32x16_bf16 v[168:183], v[120:123], v[208:211], v[168:183]
    ds_read_b64_tr_b16 v[240:241], v254 offset:0
    ds_read_b64_tr_b16 v[242:243], v254 offset:2048
    s_waitcnt lgkmcnt(10)
    v_mfma_f32_32x32x16_bf16 v[136:151], v[124:127], v[216:219], v[136:151]
    ds_read_b64_tr_b16 v[200:201], v252 offset:8192
    ds_read_b64_tr_b16 v[202:203], v252 offset:10240
    s_waitcnt lgkmcnt(10)
    v_mfma_f32_32x32x16_bf16 v[152:167], v[124:127], v[220:223], v[152:167]
    ds_read_b64_tr_b16 v[204:205], v253 offset:8192
    ds_read_b64_tr_b16 v[206:207], v253 offset:10240
    s_waitcnt lgkmcnt(10)
    v_mfma_f32_32x32x16_bf16 v[168:183], v[124:127], v[224:227], v[168:183]
    ds_read_b64_tr_b16 v[208:209], v254 offset:8192
    ds_read_b64_tr_b16 v[210:211], v254 offset:10240
    s_waitcnt vmcnt(0) lgkmcnt(0)
    s_barrier
    v_mfma_f32_32x32x16_bf16 v[136:151], v[128:131], v[232:235], v[136:151]
    v_mfma_f32_32x32x16_bf16 v[152:167], v[128:131], v[236:239], v[152:167]
    v_mfma_f32_32x32x16_bf16 v[168:183], v[128:131], v[240:243], v[168:183]
    v_mfma_f32_32x32x16_bf16 v[136:151], v[132:135], v[200:203], v[136:151]
    v_mfma_f32_32x32x16_bf16 v[152:167], v[132:135], v[204:207], v[152:167]
    v_mfma_f32_32x32x16_bf16 v[168:183], v[132:135], v[208:211], v[168:183]
    s_mul_i32 s53, s45, 28672
    s_lshl_b32 s54, s43, 9
    s_add_u32 s53, s53, s54
    s_add_u32 s53, s53, 4194304
    s_add_u32 s54, s53, 14336
    s_nop 4
    v_cvt_pk_bf16_f32 v136, v136, v137
    v_cvt_pk_bf16_f32 v137, v138, v139
    v_cvt_pk_bf16_f32 v138, v140, v141
    v_cvt_pk_bf16_f32 v139, v142, v143
    v_cvt_pk_bf16_f32 v140, v144, v145
    v_cvt_pk_bf16_f32 v141, v146, v147
    v_cvt_pk_bf16_f32 v142, v148, v149
    v_cvt_pk_bf16_f32 v143, v150, v151
    buffer_store_dwordx4 v[136:139], v15, s[24:27], s53 offen offset:0 sc1
    buffer_store_dwordx4 v[140:143], v15, s[24:27], s54 offen offset:0 sc1
    v_cvt_pk_bf16_f32 v152, v152, v153
    v_cvt_pk_bf16_f32 v153, v154, v155
    v_cvt_pk_bf16_f32 v154, v156, v157
    v_cvt_pk_bf16_f32 v155, v158, v159
    v_cvt_pk_bf16_f32 v156, v160, v161
    v_cvt_pk_bf16_f32 v157, v162, v163
    v_cvt_pk_bf16_f32 v158, v164, v165
    v_cvt_pk_bf16_f32 v159, v166, v167
    buffer_store_dwordx4 v[152:155], v15, s[24:27], s53 offen offset:512 sc1
    buffer_store_dwordx4 v[156:159], v15, s[24:27], s54 offen offset:512 sc1
    v_cvt_pk_bf16_f32 v168, v168, v169
    v_cvt_pk_bf16_f32 v169, v170, v171
    v_cvt_pk_bf16_f32 v170, v172, v173
    v_cvt_pk_bf16_f32 v171, v174, v175
    v_cvt_pk_bf16_f32 v172, v176, v177
    v_cvt_pk_bf16_f32 v173, v178, v179
    v_cvt_pk_bf16_f32 v174, v180, v181
    v_cvt_pk_bf16_f32 v175, v182, v183
    buffer_store_dwordx4 v[168:171], v15, s[24:27], s53 offen offset:1024 sc1
    buffer_store_dwordx4 v[172:175], v15, s[24:27], s54 offen offset:1024 sc1
    ds_read_b128 v[200:203], v9 offset:0
    ds_read_b128 v[204:207], v9 offset:32
    ds_read_b128 v[208:211], v9 offset:64
    ds_read_b128 v[212:215], v9 offset:96
    s_waitcnt lgkmcnt(0)
    v_mfma_f32_32x32x16_bf16 v[184:199], v[200:203], v[24:27], 0
    v_mfma_f32_32x32x16_bf16 v[184:199], v[204:207], v[28:31], v[184:199]
    v_mfma_f32_32x32x16_bf16 v[184:199], v[208:211], v[32:35], v[184:199]
    v_mfma_f32_32x32x16_bf16 v[184:199], v[212:215], v[36:39], v[184:199]
    ds_read_b128 v[216:219], v9 offset:128
    ds_read_b128 v[220:223], v9 offset:160
    ds_read_b128 v[224:227], v9 offset:192
    ds_read_b128 v[228:231], v9 offset:224
    s_waitcnt lgkmcnt(0)
    v_mfma_f32_32x32x16_bf16 v[184:199], v[216:219], v[40:43], v[184:199]
    v_mfma_f32_32x32x16_bf16 v[184:199], v[220:223], v[44:47], v[184:199]
    v_mfma_f32_32x32x16_bf16 v[184:199], v[224:227], v[48:51], v[184:199]
    v_mfma_f32_32x32x16_bf16 v[184:199], v[228:231], v[52:55], v[184:199]
    ds_read_b128 v[200:203], v9 offset:256
    ds_read_b128 v[204:207], v9 offset:288
    ds_read_b128 v[208:211], v9 offset:320
    ds_read_b128 v[212:215], v9 offset:352
    s_waitcnt lgkmcnt(0)
    v_mfma_f32_32x32x16_bf16 v[184:199], v[200:203], v[56:59], v[184:199]
    v_mfma_f32_32x32x16_bf16 v[184:199], v[204:207], v[60:63], v[184:199]
    v_mfma_f32_32x32x16_bf16 v[184:199], v[208:211], v[64:67], v[184:199]
    v_mfma_f32_32x32x16_bf16 v[184:199], v[212:215], v[68:71], v[184:199]
    ds_read_b128 v[216:219], v9 offset:384
    ds_read_b128 v[220:223], v9 offset:416
    ds_read_b128 v[224:227], v9 offset:448
    ds_read_b128 v[228:231], v9 offset:480
    s_waitcnt lgkmcnt(0)
    v_mfma_f32_32x32x16_bf16 v[184:199], v[216:219], v[72:75], v[184:199]
    v_mfma_f32_32x32x16_bf16 v[184:199], v[220:223], v[76:79], v[184:199]
    v_mfma_f32_32x32x16_bf16 v[184:199], v[224:227], v[80:83], v[184:199]
    v_mfma_f32_32x32x16_bf16 v[184:199], v[228:231], v[84:87], v[184:199]
    s_waitcnt vmcnt(0)
    s_barrier
    s_add_u32 s57, s55, 14
    s_lshl_b32 s53, s42, 4
    s_add_u32 s53, s53, s57
    s_lshl_b32 s53, s53, 7
    s_lshl_b32 s54, s3, 24
    s_add_u32 s53, s53, s54
    s_add_u32 s53, s53, 15794176
    s_mov_b64 exec, 0xffff
    buffer_store_dwordx2 v[12:13], v14, s[24:27], s53 offen sc1
    s_mov_b64 exec, -1
    ds_read_b128 v[200:203], v9 offset:512
    ds_read_b128 v[204:207], v9 offset:544
    ds_read_b128 v[208:211], v9 offset:576
    ds_read_b128 v[212:215], v9 offset:608
    s_waitcnt lgkmcnt(0)
    v_mfma_f32_32x32x16_bf16 v[184:199], v[200:203], v[88:91], v[184:199]
    v_mfma_f32_32x32x16_bf16 v[184:199], v[204:207], v[92:95], v[184:199]
    v_mfma_f32_32x32x16_bf16 v[184:199], v[208:211], v[96:99], v[184:199]
    v_mfma_f32_32x32x16_bf16 v[184:199], v[212:215], v[100:103], v[184:199]
    ds_read_b128 v[216:219], v9 offset:640
    ds_read_b128 v[220:223], v9 offset:672
    ds_read_b128 v[224:227], v9 offset:704
    ds_read_b128 v[228:231], v9 offset:736
    s_waitcnt lgkmcnt(0)
    v_mfma_f32_32x32x16_bf16 v[184:199], v[216:219], v[104:107], v[184:199]
    v_mfma_f32_32x32x16_bf16 v[184:199], v[220:223], v[108:111], v[184:199]
    v_mfma_f32_32x32x16_bf16 v[184:199], v[224:227], v[112:115], v[184:199]
    v_mfma_f32_32x32x16_bf16 v[184:199], v[228:231], v[116:119], v[184:199]
    ds_read_b128 v[200:203], v9 offset:768
    ds_read_b128 v[204:207], v9 offset:800
    ds_read_b128 v[208:211], v9 offset:832
    ds_read_b128 v[212:215], v9 offset:864
    s_waitcnt lgkmcnt(0)
    v_mfma_f32_32x32x16_bf16 v[184:199], v[200:203], v[120:123], v[184:199]
    v_mfma_f32_32x32x16_bf16 v[184:199], v[204:207], v[124:127], v[184:199]
    v_mfma_f32_32x32x16_bf16 v[184:199], v[208:211], v[128:131], v[184:199]
    v_mfma_f32_32x32x16_bf16 v[184:199], v[212:215], v[132:135], v[184:199]
    s_nop 11
    v_mul_f32 v184, 0xbfb8aa3b, v184
    v_exp_f32 v184, v184
    s_lshl_b32 s51, s55, 24
    s_lshl_b32 s52, s45, 7
    s_add_u32 s52, s51, s52
    s_add_u32 s52, s52, 15728640
    v_add_f32 v184, 1.0, v184
    v_rcp_f32 v184, v184
    s_nop 0
    buffer_store_dword v184, v10, s[24:27], s52 offen sc1
    s_lshl_b32 s52, s45, 12
    s_add_u32 s52, s51, s52
    s_add_u32 s52, s52, 15863296
    s_waitcnt vmcnt(0)
    s_mov_b64 exec, 0xffff
    buffer_store_dwordx2 v[12:13], v14, s[24:27], s52 offen sc1
    s_mov_b64 exec, -1
    s_endpgm
L_slow:
    v_lshrrev_b32 v2, 4, v1
    v_lshlrev_b32 v2, 3, v2
    v_lshrrev_b32 v2, v2, s98
    v_and_b32 v2, 0xff, v2
    v_and_b32 v4, 15, v1
    v_lshl_add_u32 v2, v4, 4, v2
    v_lshlrev_b32 v2, 7, v2
    v_add_u32 v2, 15794176, v2
    s_mov_b32 s58, 0x4000
L_poll_81:
    buffer_load_dwordx2 v[18:19], v2, s[24:27], 0 offen sc1
    s_waitcnt vmcnt(0)
    v_cmp_ne_u64 vcc, s[60:61], v[18:19]
    s_nop 4
    s_cbranch_vccz L_polld_82
    s_sleep 2
    s_sub_u32 s58, s58, 1
    s_cmp_lg_u32 s58, 0
    s_cbranch_scc1 L_poll_81
L_polld_82:
    v_mov_b32 v184, 0
    v_mov_b32 v185, 0
    v_mov_b32 v186, 0
    v_mov_b32 v187, 0
    v_mov_b32 v188, 0
    v_mov_b32 v189, 0
    v_mov_b32 v190, 0
    v_mov_b32 v191, 0
    v_mov_b32 v192, 0
    v_mov_b32 v193, 0
    v_mov_b32 v194, 0
    v_mov_b32 v195, 0
    v_mov_b32 v196, 0
    v_mov_b32 v197, 0
    v_mov_b32 v198, 0
    v_mov_b32 v199, 0
    v_mov_b32 v4, 0xff61b1e6
    s_lshl_b32 s68, s71, 9
    s_add_u32 s68, s68, 28672
    s_mul_i32 s69, s62, 448
    s_add_u32 s69, s69, 4194304
    s_mov_b32 s70, 0
L_slow_loop:
    buffer_load_dwordx4 v[136:139], v16, s[24:27], s68 offen offset:0 sc1
    buffer_load_dwordx4 v[140:143], v16, s[24:27], s68 offen offset:1024 sc1
    s_add_u32 s68, s68, 57344
    s_mov_b64 exec, s[66:67]
    buffer_load_dwordx4 v[24:27], v3, s[24:27], s69 offen sc1
    buffer_load_dwordx4 v[28:31], v23, s[24:27], s69 offen sc1
    s_mov_b64 exec, -1
    s_add_u32 s69, s69, 28672
    s_waitcnt vmcnt(0)
    v_mfma_f32_32x32x16_bf16 v[104:119], v[136:139], v[80:83], 0
    v_mfma_f32_32x32x16_bf16 v[104:119], v[140:143], v[84:87], v[104:119]
    s_nop 11
    v_max3_f32 v5, v104, v105, v4
    v_max3_f32 v5, v106, v107, v5
    v_max3_f32 v5, v108, v109, v5
    v_max3_f32 v5, v110, v111, v5
    v_max3_f32 v5, v112, v113, v5
    v_max3_f32 v5, v114, v115, v5
    v_max3_f32 v5, v116, v117, v5
    v_max3_f32 v5, v118, v119, v5
    v_mov_b32 v6, v5
    s_nop 1
    v_permlane32_swap_b32 v5, v6
    v_max_f32 v5, v5, v6
    v_sub_f32 v6, v4, v5
    v_exp_f32 v6, v6
    v_mov_b32 v4, v5
    v_mul_f32 v184, v184, v6
    v_mul_f32 v185, v185, v6
    v_mul_f32 v186, v186, v6
    v_mul_f32 v187, v187, v6
    v_mul_f32 v188, v188, v6
    v_mul_f32 v189, v189, v6
    v_mul_f32 v190, v190, v6
    v_mul_f32 v191, v191, v6
    v_mul_f32 v192, v192, v6
    v_mul_f32 v193, v193, v6
    v_mul_f32 v194, v194, v6
    v_mul_f32 v195, v195, v6
    v_mul_f32 v196, v196, v6
    v_mul_f32 v197, v197, v6
    v_mul_f32 v198, v198, v6
    v_mul_f32 v199, v199, v6
    v_sub_f32 v104, v104, v5
    v_sub_f32 v105, v105, v5
    v_sub_f32 v106, v106, v5
    v_sub_f32 v107, v107, v5
    v_sub_f32 v108, v108, v5
    v_sub_f32 v109, v109, v5
    v_sub_f32 v110, v110, v5
    v_sub_f32 v111, v111, v5
    v_sub_f32 v112, v112, v5
    v_sub_f32 v113, v113, v5
    v_sub_f32 v114, v114, v5
    v_sub_f32 v115, v115, v5
    v_sub_f32 v116, v116, v5
    v_sub_f32 v117, v117, v5
    v_sub_f32 v118, v118, v5
    v_sub_f32 v119, v119, v5
    v_exp_f32 v104, v104
    v_exp_f32 v105, v105
    v_exp_f32 v106, v106
    v_exp_f32 v107, v107
    v_exp_f32 v108, v108
    v_exp_f32 v109, v109
    v_exp_f32 v110, v110
    v_exp_f32 v111, v111
    v_exp_f32 v112, v112
    v_exp_f32 v113, v113
    v_exp_f32 v114, v114
    v_exp_f32 v115, v115
    v_exp_f32 v116, v116
    v_exp_f32 v117, v117
    v_exp_f32 v118, v118
    v_exp_f32 v119, v119
    v_cvt_pk_bf16_f32 v248, v104, v105
    v_cvt_pk_bf16_f32 v249, v106, v107
    v_cvt_pk_bf16_f32 v250, v108, v109
    v_cvt_pk_bf16_f32 v251, v110, v111
    v_cvt_pk_bf16_f32 v252, v112, v113
    v_cvt_pk_bf16_f32 v253, v114, v115
    v_cvt_pk_bf16_f32 v254, v116, v117
    v_cvt_pk_bf16_f32 v255, v118, v119
    v_mfma_f32_32x32x16_bf16 v[184:199], v[24:27], v[248:251], v[184:199]
    s_nop 0
    v_mfma_f32_32x32x16_bf16 v[184:199], v[28:31], v[252:255], v[184:199]
    s_nop 7
    s_nop 3
    s_add_u32 s70, s70, 1
    s_cmp_lt_u32 s70, 64
    s_cbranch_scc1 L_slow_loop
    v_mov_b32 v2, v196
    v_mov_b32 v9, v196
    s_nop 1
    v_permlane32_swap_b32 v2, v9
    s_branch L_ofin
L_end:
    s_endpgm
L_codeend:
.section .rodata,"a"
.p2align 6
.amdhsa_kernel gated_mix__mha_block__geglu_ffn__prompt_kernel
  .amdhsa_next_free_vgpr 256
  .amdhsa_next_free_sgpr 102
  .amdhsa_accum_offset 256
  .amdhsa_group_segment_fixed_size 0
  .amdhsa_kernarg_size 88
  .amdhsa_user_sgpr_count 2
  .amdhsa_user_sgpr_kernarg_segment_ptr 1
  .amdhsa_system_sgpr_workgroup_id_x 1
.end_amdhsa_kernel
```
